```python
import torch

def _softmax(x, axis=-1):
    return torch.softmax(x, dim=axis)
def _gelu(x):
    return torch.nn.functional.gelu(x, approximate="tanh")
def _silu(x):
    return torch.nn.functional.silu(x)
def _sigmoid(x):
    return torch.sigmoid(x)
def _layernorm(x, axis=-1, eps=1e-5):
    m = x.mean(dim=axis, keepdim=True)
    v = x.var(dim=axis, keepdim=True, unbiased=False)
    return (x - m) / torch.sqrt(v + eps)
def _scatter_add(tgt, idx, src, axis=0):
    return tgt.clone().index_add_(axis, idx, src)
def _segment_sum(src, seg, n):
    out = torch.zeros((n,) + src.shape[1:], dtype=src.dtype)
    return out.index_add_(0, seg, src)
def _pad(x, pw):
    flat = tuple(v for pair in reversed(pw) for v in pair)
    return torch.nn.functional.pad(x, flat)

kernel_name = 'sequential_preLN__softmax_full_mha__dense_activation_squared_relu__prompt'

def setup_inputs():

    _w = (lambda a: (lambda t: t.to(torch.bfloat16) if t.is_floating_point() else t)(torch.as_tensor(a)))
    def _A_setup():
        B, S, D = 1, 2048, 448
        return {
            "x": _w((lambda *s: torch.randn(*s, dtype=torch.bfloat16) * 0.05)(B, S, D)),
            "wqkv": _w((lambda *s: torch.randn(*s, dtype=torch.bfloat16) * 0.05)(D, 3 * D)),
            "wo": _w((lambda *s: torch.randn(*s, dtype=torch.bfloat16) * 0.05)(D, D)),
        }
    _A_in = _A_setup()

    def _B_setup():
        B, S, D, F = 1, 2048, 448, 1792
        return {
            "x": _w((lambda *s: torch.randn(*s, dtype=torch.bfloat16) * 0.05)(B, S, D)),
            "w1": _w((lambda *s: torch.randn(*s, dtype=torch.bfloat16) * 0.05)(D, F)),
            "b1": _w((lambda *s: torch.randn(*s, dtype=torch.bfloat16) * 0.2)(F)),
            "w2": _w((lambda *s: torch.randn(*s, dtype=torch.bfloat16) * 0.05)(F, D)),
            "b2": _w((lambda *s: torch.randn(*s, dtype=torch.bfloat16) * 0.8)(D)),
        }
    _B_in = _B_setup()

    return {
        "A_x": _A_in["x"],
        "A_wqkv": _A_in["wqkv"],
        "A_wo": _A_in["wo"],
        "B_x": _B_in["x"],
        "B_w1": _B_in["w1"],
        "B_b1": _B_in["b1"],
        "B_w2": _B_in["w2"],
        "B_b2": _B_in["b2"],
    }

def reference(A_x, A_wqkv, A_wo, B_x, B_w1, B_b1, B_w2, B_b2):
    def _A_ref(x, wqkv, wo):
        B, S, D = x.shape
        H = 16; Dh = D // H
        qkv = (lambda x, *d: x.permute(*d))((x @ wqkv).reshape(B, S, 3, H, Dh), 2, 0, 3, 1, 4)
        q, k, v = qkv[0], qkv[1], qkv[2]
        scale = Dh ** -0.5
        scores = torch.einsum("bhqd,bhkd->bhqk", q, k) * scale
        p = _softmax(scores, axis=-1)
        o = torch.einsum("bhqk,bhkd->bhqd", p, v)
        return (lambda x, *d: x.permute(*d))(o, 0, 2, 1, 3).reshape(B, S, D) @ wo

    def _B_ref(x, w1, b1, w2, b2):
        h = torch.einsum("bsd,df->bsf", x, w1) + b1
        zero = torch.zeros_like(h)
        r = torch.where(h > zero, h, zero)
        h = r * r
        out = torch.einsum("bsf,fd->bsd", h, w2) + b2
        return out

    x = A_x
    h = x + _A_ref(_layernorm(x, axis=-1), A_wqkv, A_wo)
    h2 = h + _B_ref(_layernorm(h, axis=-1), B_w1, B_b1, B_w2, B_b2)
    return h2
```

```asm
; @launch grid=(256,1,1) block=(512,1,1) lds=163840
.amdgcn_target "amdgcn-amd-amdhsa--gfx950"
.text
.globl sequential_preLN__softmax_full_mha__dense_activation_squared_relu__prompt_kernel
.p2align 8
.type sequential_preLN__softmax_full_mha__dense_activation_squared_relu__prompt_kernel,@function
sequential_preLN__softmax_full_mha__dense_activation_squared_relu__prompt_kernel:
    s_cmp_ge_u32 s2, 256
    s_cbranch_scc1 L_end
    s_load_dwordx16 s[36:51], s[0:1], 0
    s_load_dwordx4 s[52:55], s[0:1], 64
    s_load_dwordx2 s[56:57], s[0:1], 80
    s_getpc_b64 s[64:65]
L_pc:
    v_lshrrev_b32 v22, 6, v0
    v_and_b32 v1, 63, v0
    v_readfirstlane_b32 s63, v22
    v_lshlrev_b32 v2, 4, v1
    s_and_b32 s61, s2, 7
    s_lshr_b32 s62, s2, 3
    s_and_b32 s22, s62, 15
    s_lshr_b32 s23, s62, 4
    s_and_b32 s3, s63, 3
    s_lshl_b32 s20, s23, 3
    s_add_u32 s20, s20, s61
    s_lshl_b32 s21, s61, 1
    s_add_u32 s21, s21, s23
    s_lshl_b32 s24, s22, 2
    s_add_u32 s24, s24, s3
    s_add_u32 s27, s22, s20
    s_mul_i32 s28, s27, 37
    s_lshr_b32 s28, s28, 8
    s_mul_i32 s28, s28, 7
    s_sub_u32 s25, s27, s28
    s_lshl_b32 s30, s3, 12
    s_add_u32 s30, s30, 86016
    s_cmp_lt_u32 s63, 4
    s_cbranch_scc1 L_A
    v_lshrrev_b32 v22, 3, v1
    v_and_b32 v23, 7, v1
    v_mul_u32_u24 v25, 896, v22
    v_lshrrev_b32 v24, 1, v22
    v_xor_b32 v24, v23, v24
    v_lshl_add_u32 v3, v24, 4, v25
    v_xor_b32 v24, 4, v24
    v_lshl_add_u32 v4, v24, 4, v25
    v_add_u32 v4, 7168, v4
    s_mul_i32 s27, s24, 28672
    s_waitcnt lgkmcnt(0)
    s_mov_b32 s8, s36
    s_mov_b32 s9, s37
    s_mov_b32 s10, 0x1c0000
    s_mov_b32 s11, 0x00020000
    s_mov_b32 s28, s25
    s_lshl_b32 s28, s28, 7
    s_add_u32 s28, s28, s27
    s_add_u32 m0, s30, 0
    s_add_u32 s29, s28, 14336
    buffer_load_dwordx4 v3, s[8:11], s28 offen lds
    s_add_u32 m0, m0, 1024
    s_nop 0
    buffer_load_dwordx4 v4, s[8:11], s28 offen lds
    s_add_u32 m0, m0, 1024
    s_nop 0
    buffer_load_dwordx4 v3, s[8:11], s29 offen lds
    s_add_u32 m0, m0, 1024
    s_nop 0
    buffer_load_dwordx4 v4, s[8:11], s29 offen lds
    v_add_u32 v22, 0, v1
    v_mul_u32_u24 v23, 171, v22
    v_lshrrev_b32 v23, 11, v23
    v_mul_u32_u24 v24, 12, v23
    v_sub_u32 v24, v22, v24
    v_mul_u32_u24 v23, 2688, v23
    v_lshl_add_u32 v5, v24, 4, v23
    v_lshrrev_b32 v24, 2, v24
    v_mul_u32_u24 v24, 832, v24
    v_add_u32 v5, v5, v24
    v_add_u32 v22, 64, v1
    v_mul_u32_u24 v23, 171, v22
    v_lshrrev_b32 v23, 11, v23
    v_mul_u32_u24 v24, 12, v23
    v_sub_u32 v24, v22, v24
    v_mul_u32_u24 v23, 2688, v23
    v_lshl_add_u32 v6, v24, 4, v23
    v_lshrrev_b32 v24, 2, v24
    v_mul_u32_u24 v24, 832, v24
    v_add_u32 v6, v6, v24
    v_add_u32 v22, 128, v1
    v_mul_u32_u24 v23, 171, v22
    v_lshrrev_b32 v23, 11, v23
    v_mul_u32_u24 v24, 12, v23
    v_sub_u32 v24, v22, v24
    v_mul_u32_u24 v23, 2688, v23
    v_lshl_add_u32 v7, v24, 4, v23
    v_lshrrev_b32 v24, 2, v24
    v_mul_u32_u24 v24, 832, v24
    v_add_u32 v7, v7, v24
    s_mul_i32 s31, s21, 56
    s_cmp_eq_u32 s21, 15
    s_cselect_b32 s32, 8, 0
    s_sub_u32 s31, s31, s32
    s_mul_i32 s32, s3, 43008
    s_add_u32 s31, s31, s32
    s_mul_i32 s33, s3, 3072
    s_mov_b32 s12, s38
    s_mov_b32 s13, s39
    s_mov_b32 s14, 0x126000
    s_mov_b32 s15, 0x00020000
    s_mov_b32 s32, s25
    s_mul_i32 s32, s32, 172032
    s_add_u32 m0, s33, 0
    s_add_u32 s32, s32, s31
    buffer_load_dwordx4 v5, s[12:15], s32 offen lds
    s_add_u32 m0, m0, 1024
    s_nop 0
    buffer_load_dwordx4 v6, s[12:15], s32 offen lds
    s_add_u32 m0, m0, 1024
    s_nop 0
    buffer_load_dwordx4 v7, s[12:15], s32 offen lds
    s_mov_b32 s66, L_codeend-L_pc
    s_mov_b32 s67, 0x00020000
    v_lshlrev_b32 v22, 7, v1
    s_lshl_b32 s68, s62, 2
    s_add_u32 s68, s68, s3
    s_lshl_b32 s68, s68, 9
    s_mov_b64 exec, 15
    buffer_load_dword v246, v22, s[64:67], s68 offen
    s_mov_b64 exec, -1
    s_add_u32 s28, s25, 1
    s_cmp_ge_u32 s28, 7
    s_cselect_b32 s26, 7, 0
    s_sub_u32 s28, s28, s26
    s_lshl_b32 s28, s28, 7
    s_add_u32 s28, s28, s27
    s_add_u32 m0, s30, 16384
    s_add_u32 s29, s28, 14336
    buffer_load_dwordx4 v3, s[8:11], s28 offen lds
    s_add_u32 m0, m0, 1024
    s_nop 0
    buffer_load_dwordx4 v4, s[8:11], s28 offen lds
    s_add_u32 m0, m0, 1024
    s_nop 0
    buffer_load_dwordx4 v3, s[8:11], s29 offen lds
    s_add_u32 m0, m0, 1024
    s_nop 0
    buffer_load_dwordx4 v4, s[8:11], s29 offen lds
    s_add_u32 s32, s25, 1
    s_cmp_ge_u32 s32, 7
    s_cselect_b32 s26, 7, 0
    s_sub_u32 s32, s32, s26
    s_mul_i32 s32, s32, 172032
    s_add_u32 m0, s33, 12288
    s_add_u32 s32, s32, s31
    buffer_load_dwordx4 v5, s[12:15], s32 offen lds
    s_add_u32 m0, m0, 1024
    s_nop 0
    buffer_load_dwordx4 v6, s[12:15], s32 offen lds
    s_add_u32 m0, m0, 1024
    s_nop 0
    buffer_load_dwordx4 v7, s[12:15], s32 offen lds
    s_mov_b32 s16, s56
    s_mov_b32 s17, s57
    s_mov_b32 s18, 0x2000000
    s_mov_b32 s19, 0x00020000
    s_mov_b32 s64, s54
    s_mov_b32 s65, s55
    s_mov_b32 s66, 256
    s_mov_b32 s67, 0x00020000
    s_getreg_b32 s68, hwreg(HW_REG_XCC_ID, 0, 4)
    s_mul_i32 s69, s68, s68
    s_lshl_b32 s69, s69, 16
    s_lshl_b32 s68, s68, 6
    s_add_u32 s68, s68, s69
    s_add_u32 s68, s68, 1
    s_lshl_b32 s58, s68, 5
    s_lshl_b32 s35, s61, 5
    s_add_u32 s35, s35, 16
    s_lshl_b32 s71, s24, 12
    s_lshl_b32 s70, s21, 18
    s_add_u32 s71, s71, s70
    s_add_u32 s71, s71, 0x200000
    s_add_u32 s73, s71, 2048
    v_lshlrev_b32 v27, 7, v1
    v_add_u32 v28, s71, v27
    s_waitcnt vmcnt(8)
    s_barrier
    s_add_u32 s28, s25, 2
    s_cmp_ge_u32 s28, 7
    s_cselect_b32 s26, 7, 0
    s_sub_u32 s28, s28, s26
    s_lshl_b32 s28, s28, 7
    s_add_u32 s28, s28, s27
    s_add_u32 m0, s30, 32768
    s_add_u32 s29, s28, 14336
    buffer_load_dwordx4 v3, s[8:11], s28 offen lds
    s_add_u32 m0, m0, 1024
    s_nop 0
    buffer_load_dwordx4 v4, s[8:11], s28 offen lds
    s_add_u32 m0, m0, 1024
    s_nop 0
    buffer_load_dwordx4 v3, s[8:11], s29 offen lds
    s_add_u32 m0, m0, 1024
    s_nop 0
    buffer_load_dwordx4 v4, s[8:11], s29 offen lds
    s_add_u32 s32, s25, 2
    s_cmp_ge_u32 s32, 7
    s_cselect_b32 s26, 7, 0
    s_sub_u32 s32, s32, s26
    s_mul_i32 s32, s32, 172032
    s_add_u32 m0, s33, 24576
    s_add_u32 s32, s32, s31
    buffer_load_dwordx4 v5, s[12:15], s32 offen lds
    s_add_u32 m0, m0, 1024
    s_nop 0
    buffer_load_dwordx4 v6, s[12:15], s32 offen lds
    s_add_u32 m0, m0, 1024
    s_nop 0
    buffer_load_dwordx4 v7, s[12:15], s32 offen lds
    s_waitcnt vmcnt(7)
    s_barrier
    s_add_u32 s28, s25, 3
    s_cmp_ge_u32 s28, 7
    s_cselect_b32 s26, 7, 0
    s_sub_u32 s28, s28, s26
    s_lshl_b32 s28, s28, 7
    s_add_u32 s28, s28, s27
    s_add_u32 m0, s30, 49152
    s_add_u32 s29, s28, 14336
    buffer_load_dwordx4 v3, s[8:11], s28 offen lds
    s_add_u32 m0, m0, 1024
    s_nop 0
    buffer_load_dwordx4 v4, s[8:11], s28 offen lds
    s_add_u32 m0, m0, 1024
    s_nop 0
    buffer_load_dwordx4 v3, s[8:11], s29 offen lds
    s_add_u32 m0, m0, 1024
    s_nop 0
    buffer_load_dwordx4 v4, s[8:11], s29 offen lds
    s_add_u32 s32, s25, 3
    s_cmp_ge_u32 s32, 7
    s_cselect_b32 s26, 7, 0
    s_sub_u32 s32, s32, s26
    s_mul_i32 s32, s32, 172032
    s_add_u32 m0, s33, 36864
    s_add_u32 s32, s32, s31
    buffer_load_dwordx4 v5, s[12:15], s32 offen lds
    s_add_u32 m0, m0, 1024
    s_nop 0
    buffer_load_dwordx4 v6, s[12:15], s32 offen lds
    s_add_u32 m0, m0, 1024
    s_nop 0
    buffer_load_dwordx4 v7, s[12:15], s32 offen lds
    s_waitcnt vmcnt(7)
    s_barrier
    s_add_u32 s28, s25, 4
    s_cmp_ge_u32 s28, 7
    s_cselect_b32 s26, 7, 0
    s_sub_u32 s28, s28, s26
    s_lshl_b32 s28, s28, 7
    s_add_u32 s28, s28, s27
    s_add_u32 m0, s30, 0
    s_add_u32 s29, s28, 14336
    buffer_load_dwordx4 v3, s[8:11], s28 offen lds
    s_add_u32 m0, m0, 1024
    s_nop 0
    buffer_load_dwordx4 v4, s[8:11], s28 offen lds
    s_add_u32 m0, m0, 1024
    s_nop 0
    buffer_load_dwordx4 v3, s[8:11], s29 offen lds
    s_add_u32 m0, m0, 1024
    s_nop 0
    buffer_load_dwordx4 v4, s[8:11], s29 offen lds
    s_add_u32 s32, s25, 4
    s_cmp_ge_u32 s32, 7
    s_cselect_b32 s26, 7, 0
    s_sub_u32 s32, s32, s26
    s_mul_i32 s32, s32, 172032
    s_add_u32 m0, s33, 49152
    s_add_u32 s32, s32, s31
    buffer_load_dwordx4 v5, s[12:15], s32 offen lds
    s_add_u32 m0, m0, 1024
    s_nop 0
    buffer_load_dwordx4 v6, s[12:15], s32 offen lds
    s_add_u32 m0, m0, 1024
    s_nop 0
    buffer_load_dwordx4 v7, s[12:15], s32 offen lds
    s_waitcnt vmcnt(7)
    s_barrier
    s_add_u32 s28, s25, 5
    s_cmp_ge_u32 s28, 7
    s_cselect_b32 s26, 7, 0
    s_sub_u32 s28, s28, s26
    s_lshl_b32 s28, s28, 7
    s_add_u32 s28, s28, s27
    s_add_u32 m0, s30, 16384
    s_add_u32 s29, s28, 14336
    buffer_load_dwordx4 v3, s[8:11], s28 offen lds
    s_add_u32 m0, m0, 1024
    s_nop 0
    buffer_load_dwordx4 v4, s[8:11], s28 offen lds
    s_add_u32 m0, m0, 1024
    s_nop 0
    buffer_load_dwordx4 v3, s[8:11], s29 offen lds
    s_add_u32 m0, m0, 1024
    s_nop 0
    buffer_load_dwordx4 v4, s[8:11], s29 offen lds
    s_add_u32 s32, s25, 5
    s_cmp_ge_u32 s32, 7
    s_cselect_b32 s26, 7, 0
    s_sub_u32 s32, s32, s26
    s_mul_i32 s32, s32, 172032
    s_add_u32 m0, s33, 61440
    s_add_u32 s32, s32, s31
    buffer_load_dwordx4 v5, s[12:15], s32 offen lds
    s_add_u32 m0, m0, 1024
    s_nop 0
    buffer_load_dwordx4 v6, s[12:15], s32 offen lds
    s_add_u32 m0, m0, 1024
    s_nop 0
    buffer_load_dwordx4 v7, s[12:15], s32 offen lds
    s_waitcnt vmcnt(7)
    s_barrier
    s_add_u32 s28, s25, 6
    s_cmp_ge_u32 s28, 7
    s_cselect_b32 s26, 7, 0
    s_sub_u32 s28, s28, s26
    s_lshl_b32 s28, s28, 7
    s_add_u32 s28, s28, s27
    s_add_u32 m0, s30, 32768
    s_add_u32 s29, s28, 14336
    buffer_load_dwordx4 v3, s[8:11], s28 offen lds
    s_add_u32 m0, m0, 1024
    s_nop 0
    buffer_load_dwordx4 v4, s[8:11], s28 offen lds
    s_add_u32 m0, m0, 1024
    s_nop 0
    buffer_load_dwordx4 v3, s[8:11], s29 offen lds
    s_add_u32 m0, m0, 1024
    s_nop 0
    buffer_load_dwordx4 v4, s[8:11], s29 offen lds
    s_add_u32 s32, s25, 6
    s_cmp_ge_u32 s32, 7
    s_cselect_b32 s26, 7, 0
    s_sub_u32 s32, s32, s26
    s_mul_i32 s32, s32, 172032
    s_add_u32 m0, s33, 73728
    s_add_u32 s32, s32, s31
    buffer_load_dwordx4 v5, s[12:15], s32 offen lds
    s_add_u32 m0, m0, 1024
    s_nop 0
    buffer_load_dwordx4 v6, s[12:15], s32 offen lds
    s_add_u32 m0, m0, 1024
    s_nop 0
    buffer_load_dwordx4 v7, s[12:15], s32 offen lds
    s_waitcnt vmcnt(7)
    s_barrier
    buffer_load_dword v32, off, s[64:67], 0 sc1
    buffer_load_dword v33, off, s[64:67], s35 sc1
    s_lshl_b32 s96, s2, 2
    s_add_u32 s96, s96, s3
    s_mul_i32 s97, s96, 1664
    s_lshl_b32 s96, s96, 9
    v_lshlrev_b32 v22, 7, v1
    s_mov_b64 exec, 0x1fff
    s_mov_b32 s4, s48
    s_mov_b32 s5, s49
    s_mov_b32 s6, 0x188000
    s_mov_b32 s7, 0x00020000
    buffer_load_dword v246, v22, s[4:7], s97 offen
    s_mov_b32 s4, s44
    s_mov_b32 s5, s45
    s_mov_b32 s6, 0x188000
    s_mov_b32 s7, 0x00020000
    buffer_load_dword v246, v22, s[4:7], s97 offen
    s_mov_b32 s4, s40
    s_mov_b32 s5, s41
    s_mov_b32 s6, 0x62000
    s_mov_b32 s7, 0x00020000
    s_mov_b64 exec, 15
    buffer_load_dword v246, v22, s[4:7], s96 offen
    s_mov_b64 exec, -1
    s_waitcnt vmcnt(5)
    s_barrier
    s_waitcnt vmcnt(3)
    s_mov_b32 s34, 100000
L_nonce:
    v_readfirstlane_b32 s60, v32
    v_readfirstlane_b32 s59, v33
    s_nop 3
    s_and_b32 s28, s59, 63
    s_cmp_eq_u32 s28, 32
    s_cselect_b32 s28, s60, 0
    s_min_u32 s28, s28, s60
    s_cmp_lg_u32 s28, 0
    s_cbranch_scc1 L_nonceok
    s_sub_u32 s34, s34, 1
    s_cbranch_scc1 L_nonceok
    buffer_load_dword v32, off, s[64:67], 0 sc1
    buffer_load_dword v33, off, s[64:67], s35 sc1
    s_waitcnt vmcnt(0)
    s_branch L_nonce
L_nonceok:
    s_cmp_eq_u32 s59, s58
    s_cselect_b32 s59, 1, 0
    s_lshl_b32 s28, s3, 3
    s_add_u32 s28, s28, 158208
    v_mov_b32 v29, s28
    v_mov_b32 v34, s60
    v_mov_b32 v35, s59
    ds_write_b64 v29, v[34:35]
    s_waitcnt lgkmcnt(0)
    s_barrier
    s_barrier
    s_branch L_B2
L_A:
    s_waitcnt lgkmcnt(0)
    s_mov_b32 s64, s54
    s_mov_b32 s65, s55
    s_mov_b32 s66, 256
    s_mov_b32 s67, 0x00020000
    s_getreg_b32 s68, hwreg(HW_REG_XCC_ID, 0, 4)
    s_mul_i32 s69, s68, s68
    s_lshl_b32 s69, s69, 16
    s_lshl_b32 s68, s68, 6
    s_add_u32 s68, s68, s69
    s_add_u32 s68, s68, 1
    s_lshl_b32 s58, s68, 5
    s_lshl_b32 s35, s61, 5
    s_add_u32 s35, s35, 16
    s_cmp_lg_u32 s3, 0
    s_cbranch_scc1 L_nononce
    v_mov_b32 v22, s68
    s_mov_b64 exec, 1
    buffer_atomic_add v22, off, s[64:67], s35 sc1
    s_mov_b64 exec, -1
    s_cmp_lg_u32 s2, 0
    s_cbranch_scc1 L_nononce
    s_memrealtime s[68:69]
    s_waitcnt lgkmcnt(0)
    s_or_b32 s68, s68, 1
    v_mov_b32 v22, s68
    s_mov_b64 exec, 1
    buffer_store_dword v22, off, s[64:67], 0 sc1
    s_mov_b64 exec, -1
L_nononce:
    v_and_b32 v22, 31, v1
    v_lshrrev_b32 v23, 5, v1
    v_bfe_u32 v24, v1, 1, 3
    v_xor_b32 v24, v24, v23
    v_lshlrev_b32 v25, 7, v22
    v_add_u32 v25, s30, v25
    v_xor_b32 v26, 0, v24
    v_lshl_add_u32 v8, v26, 4, v25
    v_xor_b32 v26, 2, v24
    v_lshl_add_u32 v9, v26, 4, v25
    v_xor_b32 v26, 4, v24
    v_lshl_add_u32 v10, v26, 4, v25
    v_xor_b32 v26, 6, v24
    v_lshl_add_u32 v11, v26, 4, v25
    v_bfe_u32 v26, v1, 2, 2
    v_lshl_add_u32 v26, v23, 3, v26
    v_mul_u32_u24 v12, 192, v26
    v_bfe_u32 v26, v1, 4, 1
    v_lshl_add_u32 v12, v26, 5, v12
    v_and_b32 v26, 3, v1
    v_lshl_add_u32 v12, v26, 3, v12
    s_cmp_eq_u32 s21, 15
    s_cselect_b32 s33, 8, 0
    v_add_u32 v12, s33, v12
    v_add_u32 v13, 49152, v12
    s_mul_i32 s33, s3, 3072
    v_add_u32 v3, s33, v12
    v_add_u32 v4, s33, v13
    v_and_b32 v26, 0x33, v1
    v_bfe_u32 v27, v1, 2, 1
    v_lshl_or_b32 v26, v27, 3, v26
    v_bfe_u32 v27, v1, 3, 1
    v_lshl_or_b32 v26, v27, 2, v26
    v_lshlrev_b32 v14, 4, v26
    v_mov_b32 v21, 0x3f803f80
    v_cmp_eq_u32 vcc, 28, v22
    s_lshl_b32 s28, s3, 11
    v_add_u32 v245, s28, v2
    v_cndmask_b32 v15, 0, v21, vcc
    v_lshlrev_b32 v16, 4, v22
    v_add_u32 v16, 151552, v16
    s_lshl_b32 s28, s3, 2
    v_add_u32 v17, s28, v16
    s_lshl_b32 s28, s3, 7
    s_add_u32 s28, s28, 157696
    v_lshl_add_u32 v18, v22, 2, s28
    v_lshl_add_u32 v19, v23, 4, s28
    s_lshl_b32 s28, s3, 3
    s_add_u32 s28, s28, 158208
    v_mov_b32 v31, s28
    v_mov_b32 v5, 0
    v_mov_b32 v6, 0
    v_mov_b32 v7, 0
    v_mov_b32 v20, 0
    v_mov_b32 v32, 0
    v_mov_b32 v33, 0
    v_mov_b32 v34, 0
    s_lshl_b32 s71, s24, 12
    s_lshl_b32 s70, s21, 18
    s_add_u32 s71, s71, s70
    s_add_u32 s71, s71, 0x200000
    s_add_u32 s73, s71, 2048
    s_lshl_b32 s70, s21, 6
    s_add_u32 s70, s70, s24
    s_lshl_b32 s70, s70, 2
    s_add_u32 s70, s70, 0x1600000
    s_waitcnt lgkmcnt(0)
    s_mov_b32 s16, s56
    s_mov_b32 s17, s57
    s_mov_b32 s18, 0x2000000
    s_mov_b32 s19, 0x00020000
    s_lshl_b32 s29, s21, 18
    s_lshl_b32 s28, s3, 12
    s_add_u32 s28, s28, s29
    s_add_u32 s28, s28, 0x200000
    s_lshl_b32 s29, s22, 14
    s_mov_b32 s27, 0
    s_cmp_ge_u32 s27, s29
    s_cselect_b32 s27, 16384, s27
    s_add_u32 s27, s27, s28
    s_add_u32 s36, s56, s27
    s_addc_u32 s37, s57, 0
    s_mov_b32 s27, 16384
    s_cmp_ge_u32 s27, s29
    s_cselect_b32 s27, 32768, s27
    s_add_u32 s27, s27, s28
    s_add_u32 s38, s56, s27
    s_addc_u32 s39, s57, 0
    s_mov_b32 s27, 32768
    s_cmp_ge_u32 s27, s29
    s_cselect_b32 s27, 49152, s27
    s_add_u32 s27, s27, s28
    s_add_u32 s40, s56, s27
    s_addc_u32 s41, s57, 0
    s_mov_b32 s27, 49152
    s_cmp_ge_u32 s27, s29
    s_cselect_b32 s27, 65536, s27
    s_add_u32 s27, s27, s28
    s_add_u32 s42, s56, s27
    s_addc_u32 s43, s57, 0
    s_mov_b32 s27, 65536
    s_cmp_ge_u32 s27, s29
    s_cselect_b32 s27, 81920, s27
    s_add_u32 s27, s27, s28
    s_add_u32 s44, s56, s27
    s_addc_u32 s45, s57, 0
    s_mov_b32 s27, 81920
    s_cmp_ge_u32 s27, s29
    s_cselect_b32 s27, 98304, s27
    s_add_u32 s27, s27, s28
    s_add_u32 s46, s56, s27
    s_addc_u32 s47, s57, 0
    s_mov_b32 s27, 98304
    s_cmp_ge_u32 s27, s29
    s_cselect_b32 s27, 114688, s27
    s_add_u32 s27, s27, s28
    s_add_u32 s66, s56, s27
    s_addc_u32 s67, s57, 0
    s_mov_b32 s27, 114688
    s_cmp_ge_u32 s27, s29
    s_cselect_b32 s27, 131072, s27
    s_add_u32 s27, s27, s28
    s_add_u32 s4, s56, s27
    s_addc_u32 s5, s57, 0
    s_mov_b32 s27, 131072
    s_cmp_ge_u32 s27, s29
    s_cselect_b32 s27, 147456, s27
    s_add_u32 s27, s27, s28
    s_add_u32 s6, s56, s27
    s_addc_u32 s7, s57, 0
    s_mov_b32 s27, 147456
    s_cmp_ge_u32 s27, s29
    s_cselect_b32 s27, 163840, s27
    s_add_u32 s27, s27, s28
    s_add_u32 s8, s56, s27
    s_addc_u32 s9, s57, 0
    s_mov_b32 s27, 163840
    s_cmp_ge_u32 s27, s29
    s_cselect_b32 s27, 180224, s27
    s_add_u32 s27, s27, s28
    s_add_u32 s10, s56, s27
    s_addc_u32 s11, s57, 0
    s_mov_b32 s27, 180224
    s_cmp_ge_u32 s27, s29
    s_cselect_b32 s27, 196608, s27
    s_add_u32 s27, s27, s28
    s_add_u32 s12, s56, s27
    s_addc_u32 s13, s57, 0
    s_mov_b32 s27, 196608
    s_cmp_ge_u32 s27, s29
    s_cselect_b32 s27, 212992, s27
    s_add_u32 s27, s27, s28
    s_add_u32 s14, s56, s27
    s_addc_u32 s15, s57, 0
    s_mov_b32 s27, 212992
    s_cmp_ge_u32 s27, s29
    s_cselect_b32 s27, 229376, s27
    s_add_u32 s27, s27, s28
    s_add_u32 s24, s56, s27
    s_addc_u32 s25, s57, 0
    s_mov_b32 s27, 229376
    s_cmp_ge_u32 s27, s29
    s_cselect_b32 s27, 245760, s27
    s_add_u32 s27, s27, s28
    s_add_u32 s30, s56, s27
    s_addc_u32 s31, s57, 0
    s_add_u32 s76, s3, 1
    s_and_b32 s76, s76, 3
    s_add_u32 s77, s3, 2
    s_and_b32 s77, s77, 3
    s_add_u32 s78, s3, 3
    s_and_b32 s78, s78, 3
    s_add_u32 s79, s3, 4
    s_and_b32 s79, s79, 3
    v_mov_b32 v116, 0
    v_mov_b32 v117, 0
    v_mov_b32 v118, 0
    v_mov_b32 v119, 0
    v_mov_b32 v120, 0
    v_mov_b32 v121, 0
    v_mov_b32 v122, 0
    v_mov_b32 v123, 0
    v_mov_b32 v124, 0
    v_mov_b32 v125, 0
    v_mov_b32 v126, 0
    v_mov_b32 v127, 0
    v_mov_b32 v128, 0
    v_mov_b32 v129, 0
    v_mov_b32 v130, 0
    v_mov_b32 v131, 0
    v_mov_b32 v132, 0
    v_mov_b32 v133, 0
    v_mov_b32 v134, 0
    v_mov_b32 v135, 0
    v_mov_b32 v136, 0
    v_mov_b32 v137, 0
    v_mov_b32 v138, 0
    v_mov_b32 v139, 0
    v_mov_b32 v140, 0
    v_mov_b32 v141, 0
    v_mov_b32 v142, 0
    v_mov_b32 v143, 0
    v_mov_b32 v144, 0
    v_mov_b32 v145, 0
    v_mov_b32 v146, 0
    v_mov_b32 v147, 0
    v_mov_b32 v148, 0
    v_mov_b32 v149, 0
    v_mov_b32 v150, 0
    v_mov_b32 v151, 0
    v_mov_b32 v152, 0
    v_mov_b32 v153, 0
    v_mov_b32 v154, 0
    v_mov_b32 v155, 0
    v_mov_b32 v156, 0
    v_mov_b32 v157, 0
    v_mov_b32 v158, 0
    v_mov_b32 v159, 0
    v_mov_b32 v160, 0
    v_mov_b32 v161, 0
    v_mov_b32 v162, 0
    v_mov_b32 v163, 0
    v_mov_b32 v164, 0
    v_mov_b32 v165, 0
    v_mov_b32 v166, 0
    v_mov_b32 v167, 0
    v_mov_b32 v168, 0
    v_mov_b32 v169, 0
    v_mov_b32 v170, 0
    v_mov_b32 v171, 0
    v_mov_b32 v172, 0
    v_mov_b32 v173, 0
    v_mov_b32 v174, 0
    v_mov_b32 v175, 0
    v_mov_b32 v176, 0
    v_mov_b32 v177, 0
    v_mov_b32 v178, 0
    v_mov_b32 v179, 0
    s_barrier
    ds_read_b128 v[72:75], v8 offset:0
    ds_read_b64_tr_b16 v[36:37], v12 offset:0
    ds_read_b64_tr_b16 v[38:39], v12 offset:768
    ds_read_b64_tr_b16 v[40:41], v12 offset:64
    ds_read_b64_tr_b16 v[42:43], v12 offset:832
    ds_read_b64_tr_b16 v[44:45], v12 offset:128
    ds_read_b64_tr_b16 v[46:47], v12 offset:896
    ds_read_b128 v[76:79], v9 offset:0
    ds_read_b64_tr_b16 v[48:49], v12 offset:3072
    ds_read_b64_tr_b16 v[50:51], v12 offset:3840
    ds_read_b64_tr_b16 v[52:53], v12 offset:3136
    ds_read_b64_tr_b16 v[54:55], v12 offset:3904
    ds_read_b64_tr_b16 v[56:57], v12 offset:3200
    ds_read_b64_tr_b16 v[58:59], v12 offset:3968
    s_waitcnt lgkmcnt(7)
    v_mfma_f32_32x32x16_bf16 v[196:211], v[36:39], v[72:75], 0
    ds_read_b128 v[80:83], v10 offset:0
    ds_read_b64_tr_b16 v[60:61], v12 offset:6144
    ds_read_b64_tr_b16 v[62:63], v12 offset:6912
    v_mfma_f32_32x32x16_bf16 v[212:227], v[40:43], v[72:75], 0
    ds_read_b64_tr_b16 v[64:65], v12 offset:6208
    ds_read_b64_tr_b16 v[66:67], v12 offset:6976
    v_mfma_f32_32x32x16_bf16 v[228:243], v[72:75], v[44:47], 0
    ds_read_b64_tr_b16 v[68:69], v12 offset:6272
    ds_read_b64_tr_b16 v[70:71], v12 offset:7040
    s_waitcnt lgkmcnt(7)
    v_mfma_f32_32x32x16_bf16 v[196:211], v[48:51], v[76:79], v[196:211]
    ds_read_b128 v[84:87], v11 offset:0
    ds_read_b64_tr_b16 v[36:37], v12 offset:9216
    ds_read_b64_tr_b16 v[38:39], v12 offset:9984
    v_mfma_f32_32x32x16_bf16 v[212:227], v[52:55], v[76:79], v[212:227]
    ds_read_b64_tr_b16 v[40:41], v12 offset:9280
    ds_read_b64_tr_b16 v[42:43], v12 offset:10048
    v_mfma_f32_32x32x16_bf16 v[228:243], v[76:79], v[56:59], v[228:243]
    ds_read_b64_tr_b16 v[44:45], v12 offset:9344
    ds_read_b64_tr_b16 v[46:47], v12 offset:10112
    s_waitcnt lgkmcnt(7)
    v_mfma_f32_32x32x16_bf16 v[196:211], v[60:63], v[80:83], v[196:211]
    ds_read_b64_tr_b16 v[104:105], v3 offset:0
    ds_read_b64_tr_b16 v[106:107], v3 offset:768
    ds_read_b64_tr_b16 v[108:109], v3 offset:64
    v_mfma_f32_32x32x16_bf16 v[212:227], v[64:67], v[80:83], v[212:227]
    ds_read_b64_tr_b16 v[110:111], v3 offset:832
    ds_read_b64_tr_b16 v[112:113], v3 offset:128
    v_mfma_f32_32x32x16_bf16 v[228:243], v[80:83], v[68:71], v[228:243]
    ds_read_b64_tr_b16 v[114:115], v3 offset:896
    s_waitcnt lgkmcnt(6)
    v_mfma_f32_32x32x16_bf16 v[196:211], v[36:39], v[84:87], v[196:211]
    v_mfma_f32_32x32x16_bf16 v[212:227], v[40:43], v[84:87], v[212:227]
    v_mfma_f32_32x32x16_bf16 v[228:243], v[84:87], v[44:47], v[228:243]
    s_waitcnt lgkmcnt(0)
    s_barrier
    ds_read_b128 v[88:91], v8 offset:16384
    ds_read_b64_tr_b16 v[48:49], v12 offset:12288
    ds_read_b64_tr_b16 v[50:51], v12 offset:13056
    ds_read_b64_tr_b16 v[52:53], v12 offset:12352
    ds_read_b64_tr_b16 v[54:55], v12 offset:13120
    ds_read_b64_tr_b16 v[56:57], v12 offset:12416
    ds_read_b64_tr_b16 v[58:59], v12 offset:13184
    ds_read_b128 v[92:95], v9 offset:16384
    ds_read_b64_tr_b16 v[60:61], v12 offset:15360
    ds_read_b64_tr_b16 v[62:63], v12 offset:16128
    ds_read_b64_tr_b16 v[64:65], v12 offset:15424
    ds_read_b64_tr_b16 v[66:67], v12 offset:16192
    ds_read_b64_tr_b16 v[68:69], v12 offset:15488
    ds_read_b64_tr_b16 v[70:71], v12 offset:16256
    v_dot2c_f32_bf16 v5, v72, v21
    v_dot2c_f32_bf16 v7, v72, v72
    v_dot2c_f32_bf16 v6, v73, v21
    v_dot2c_f32_bf16 v20, v73, v73
    v_dot2c_f32_bf16 v5, v74, v21
    v_dot2c_f32_bf16 v7, v74, v74
    v_dot2c_f32_bf16 v6, v75, v21
    v_dot2c_f32_bf16 v20, v75, v75
    v_dot2c_f32_bf16 v5, v76, v21
    v_dot2c_f32_bf16 v7, v76, v76
    v_dot2c_f32_bf16 v6, v77, v21
    v_dot2c_f32_bf16 v20, v77, v77
    v_dot2c_f32_bf16 v5, v78, v21
    v_dot2c_f32_bf16 v7, v78, v78
    v_dot2c_f32_bf16 v6, v79, v21
    v_dot2c_f32_bf16 v20, v79, v79
    v_dot2c_f32_bf16 v5, v80, v21
    v_dot2c_f32_bf16 v7, v80, v80
    v_dot2c_f32_bf16 v6, v81, v21
    v_dot2c_f32_bf16 v20, v81, v81
    v_dot2c_f32_bf16 v5, v82, v21
    v_dot2c_f32_bf16 v7, v82, v82
    v_dot2c_f32_bf16 v6, v83, v21
    v_dot2c_f32_bf16 v20, v83, v83
    v_dot2c_f32_bf16 v5, v84, v21
    v_dot2c_f32_bf16 v7, v84, v84
    v_dot2c_f32_bf16 v6, v85, v21
    v_dot2c_f32_bf16 v20, v85, v85
    v_dot2c_f32_bf16 v5, v86, v21
    v_dot2c_f32_bf16 v7, v86, v86
    v_dot2c_f32_bf16 v6, v87, v21
    v_dot2c_f32_bf16 v20, v87, v87
    v_dot2c_f32_bf16 v32, v104, v21
    v_dot2c_f32_bf16 v33, v108, v21
    v_dot2c_f32_bf16 v34, v112, v21
    v_dot2c_f32_bf16 v32, v105, v21
    v_dot2c_f32_bf16 v33, v109, v21
    v_dot2c_f32_bf16 v34, v113, v21
    v_dot2c_f32_bf16 v32, v106, v21
    v_dot2c_f32_bf16 v33, v110, v21
    v_dot2c_f32_bf16 v34, v114, v21
    v_dot2c_f32_bf16 v32, v107, v21
    v_dot2c_f32_bf16 v33, v111, v21
    v_dot2c_f32_bf16 v34, v115, v21
    s_waitcnt lgkmcnt(7)
    v_mfma_f32_32x32x16_bf16 v[196:211], v[48:51], v[88:91], v[196:211]
    ds_read_b128 v[96:99], v10 offset:16384
    ds_read_b64_tr_b16 v[36:37], v12 offset:18432
    ds_read_b64_tr_b16 v[38:39], v12 offset:19200
    v_mfma_f32_32x32x16_bf16 v[212:227], v[52:55], v[88:91], v[212:227]
    ds_read_b64_tr_b16 v[40:41], v12 offset:18496
    ds_read_b64_tr_b16 v[42:43], v12 offset:19264
    v_mfma_f32_32x32x16_bf16 v[228:243], v[88:91], v[56:59], v[228:243]
    ds_read_b64_tr_b16 v[44:45], v12 offset:18560
    ds_read_b64_tr_b16 v[46:47], v12 offset:19328
    s_waitcnt lgkmcnt(7)
    v_mfma_f32_32x32x16_bf16 v[196:211], v[60:63], v[92:95], v[196:211]
    ds_read_b128 v[100:103], v11 offset:16384
    ds_read_b64_tr_b16 v[48:49], v12 offset:21504
    ds_read_b64_tr_b16 v[50:51], v12 offset:22272
    v_mfma_f32_32x32x16_bf16 v[212:227], v[64:67], v[92:95], v[212:227]
    ds_read_b64_tr_b16 v[52:53], v12 offset:21568
    ds_read_b64_tr_b16 v[54:55], v12 offset:22336
    v_mfma_f32_32x32x16_bf16 v[228:243], v[92:95], v[68:71], v[228:243]
    ds_read_b64_tr_b16 v[56:57], v12 offset:21632
    ds_read_b64_tr_b16 v[58:59], v12 offset:22400
    s_waitcnt lgkmcnt(7)
    v_mfma_f32_32x32x16_bf16 v[196:211], v[36:39], v[96:99], v[196:211]
    ds_read_b64_tr_b16 v[104:105], v3 offset:12288
    ds_read_b64_tr_b16 v[106:107], v3 offset:13056
    ds_read_b64_tr_b16 v[108:109], v3 offset:12352
    v_mfma_f32_32x32x16_bf16 v[212:227], v[40:43], v[96:99], v[212:227]
    ds_read_b64_tr_b16 v[110:111], v3 offset:13120
    ds_read_b64_tr_b16 v[112:113], v3 offset:12416
    v_mfma_f32_32x32x16_bf16 v[228:243], v[96:99], v[44:47], v[228:243]
    ds_read_b64_tr_b16 v[114:115], v3 offset:13184
    s_waitcnt lgkmcnt(6)
    v_mfma_f32_32x32x16_bf16 v[196:211], v[48:51], v[100:103], v[196:211]
    v_mfma_f32_32x32x16_bf16 v[212:227], v[52:55], v[100:103], v[212:227]
    v_mfma_f32_32x32x16_bf16 v[228:243], v[100:103], v[56:59], v[228:243]
    s_waitcnt lgkmcnt(0)
    s_barrier
    ds_read_b128 v[72:75], v8 offset:32768
    ds_read_b64_tr_b16 v[60:61], v12 offset:24576
    ds_read_b64_tr_b16 v[62:63], v12 offset:25344
    ds_read_b64_tr_b16 v[64:65], v12 offset:24640
    ds_read_b64_tr_b16 v[66:67], v12 offset:25408
    ds_read_b64_tr_b16 v[68:69], v12 offset:24704
    ds_read_b64_tr_b16 v[70:71], v12 offset:25472
    ds_read_b128 v[76:79], v9 offset:32768
    ds_read_b64_tr_b16 v[36:37], v12 offset:27648
    ds_read_b64_tr_b16 v[38:39], v12 offset:28416
    ds_read_b64_tr_b16 v[40:41], v12 offset:27712
    ds_read_b64_tr_b16 v[42:43], v12 offset:28480
    ds_read_b64_tr_b16 v[44:45], v12 offset:27776
    ds_read_b64_tr_b16 v[46:47], v12 offset:28544
    v_dot2c_f32_bf16 v5, v88, v21
    v_dot2c_f32_bf16 v7, v88, v88
    v_dot2c_f32_bf16 v6, v89, v21
    v_dot2c_f32_bf16 v20, v89, v89
    v_dot2c_f32_bf16 v5, v90, v21
    v_dot2c_f32_bf16 v7, v90, v90
    v_dot2c_f32_bf16 v6, v91, v21
    v_dot2c_f32_bf16 v20, v91, v91
    v_dot2c_f32_bf16 v5, v92, v21
    v_dot2c_f32_bf16 v7, v92, v92
    v_dot2c_f32_bf16 v6, v93, v21
    v_dot2c_f32_bf16 v20, v93, v93
    v_dot2c_f32_bf16 v5, v94, v21
    v_dot2c_f32_bf16 v7, v94, v94
    v_dot2c_f32_bf16 v6, v95, v21
    v_dot2c_f32_bf16 v20, v95, v95
    v_dot2c_f32_bf16 v5, v96, v21
    v_dot2c_f32_bf16 v7, v96, v96
    v_dot2c_f32_bf16 v6, v97, v21
    v_dot2c_f32_bf16 v20, v97, v97
    v_dot2c_f32_bf16 v5, v98, v21
    v_dot2c_f32_bf16 v7, v98, v98
    v_dot2c_f32_bf16 v6, v99, v21
    v_dot2c_f32_bf16 v20, v99, v99
    v_dot2c_f32_bf16 v5, v100, v21
    v_dot2c_f32_bf16 v7, v100, v100
    v_dot2c_f32_bf16 v6, v101, v21
    v_dot2c_f32_bf16 v20, v101, v101
    v_dot2c_f32_bf16 v5, v102, v21
    v_dot2c_f32_bf16 v7, v102, v102
    v_dot2c_f32_bf16 v6, v103, v21
    v_dot2c_f32_bf16 v20, v103, v103
    v_dot2c_f32_bf16 v32, v104, v21
    v_dot2c_f32_bf16 v33, v108, v21
    v_dot2c_f32_bf16 v34, v112, v21
    v_dot2c_f32_bf16 v32, v105, v21
    v_dot2c_f32_bf16 v33, v109, v21
    v_dot2c_f32_bf16 v34, v113, v21
    v_dot2c_f32_bf16 v32, v106, v21
    v_dot2c_f32_bf16 v33, v110, v21
    v_dot2c_f32_bf16 v34, v114, v21
    v_dot2c_f32_bf16 v32, v107, v21
    v_dot2c_f32_bf16 v33, v111, v21
    v_dot2c_f32_bf16 v34, v115, v21
    s_waitcnt lgkmcnt(7)
    v_mfma_f32_32x32x16_bf16 v[196:211], v[60:63], v[72:75], v[196:211]
    ds_read_b128 v[80:83], v10 offset:32768
    ds_read_b64_tr_b16 v[48:49], v12 offset:30720
    ds_read_b64_tr_b16 v[50:51], v12 offset:31488
    v_mfma_f32_32x32x16_bf16 v[212:227], v[64:67], v[72:75], v[212:227]
    ds_read_b64_tr_b16 v[52:53], v12 offset:30784
    ds_read_b64_tr_b16 v[54:55], v12 offset:31552
    v_mfma_f32_32x32x16_bf16 v[228:243], v[72:75], v[68:71], v[228:243]
    ds_read_b64_tr_b16 v[56:57], v12 offset:30848
    ds_read_b64_tr_b16 v[58:59], v12 offset:31616
    s_waitcnt lgkmcnt(7)
    v_mfma_f32_32x32x16_bf16 v[196:211], v[36:39], v[76:79], v[196:211]
    ds_read_b128 v[84:87], v11 offset:32768
    ds_read_b64_tr_b16 v[60:61], v12 offset:33792
    ds_read_b64_tr_b16 v[62:63], v12 offset:34560
    v_mfma_f32_32x32x16_bf16 v[212:227], v[40:43], v[76:79], v[212:227]
    ds_read_b64_tr_b16 v[64:65], v12 offset:33856
    ds_read_b64_tr_b16 v[66:67], v12 offset:34624
    v_mfma_f32_32x32x16_bf16 v[228:243], v[76:79], v[44:47], v[228:243]
    ds_read_b64_tr_b16 v[68:69], v12 offset:33920
    ds_read_b64_tr_b16 v[70:71], v12 offset:34688
    s_waitcnt lgkmcnt(7)
    v_mfma_f32_32x32x16_bf16 v[196:211], v[48:51], v[80:83], v[196:211]
    ds_read_b64_tr_b16 v[104:105], v3 offset:24576
    ds_read_b64_tr_b16 v[106:107], v3 offset:25344
    ds_read_b64_tr_b16 v[108:109], v3 offset:24640
    v_mfma_f32_32x32x16_bf16 v[212:227], v[52:55], v[80:83], v[212:227]
    ds_read_b64_tr_b16 v[110:111], v3 offset:25408
    ds_read_b64_tr_b16 v[112:113], v3 offset:24704
    v_mfma_f32_32x32x16_bf16 v[228:243], v[80:83], v[56:59], v[228:243]
    ds_read_b64_tr_b16 v[114:115], v3 offset:25472
    s_waitcnt lgkmcnt(6)
    v_mfma_f32_32x32x16_bf16 v[196:211], v[60:63], v[84:87], v[196:211]
    v_mfma_f32_32x32x16_bf16 v[212:227], v[64:67], v[84:87], v[212:227]
    v_mfma_f32_32x32x16_bf16 v[228:243], v[84:87], v[68:71], v[228:243]
    s_waitcnt lgkmcnt(0)
    s_barrier
    ds_read_b128 v[88:91], v8 offset:49152
    ds_read_b64_tr_b16 v[36:37], v12 offset:36864
    ds_read_b64_tr_b16 v[38:39], v12 offset:37632
    ds_read_b64_tr_b16 v[40:41], v12 offset:36928
    ds_read_b64_tr_b16 v[42:43], v12 offset:37696
    ds_read_b64_tr_b16 v[44:45], v12 offset:36992
    ds_read_b64_tr_b16 v[46:47], v12 offset:37760
    ds_read_b128 v[92:95], v9 offset:49152
    ds_read_b64_tr_b16 v[48:49], v12 offset:39936
    ds_read_b64_tr_b16 v[50:51], v12 offset:40704
    ds_read_b64_tr_b16 v[52:53], v12 offset:40000
    ds_read_b64_tr_b16 v[54:55], v12 offset:40768
    ds_read_b64_tr_b16 v[56:57], v12 offset:40064
    ds_read_b64_tr_b16 v[58:59], v12 offset:40832
    v_dot2c_f32_bf16 v5, v72, v21
    v_dot2c_f32_bf16 v7, v72, v72
    v_dot2c_f32_bf16 v6, v73, v21
    v_dot2c_f32_bf16 v20, v73, v73
    v_dot2c_f32_bf16 v5, v74, v21
    v_dot2c_f32_bf16 v7, v74, v74
    v_dot2c_f32_bf16 v6, v75, v21
    v_dot2c_f32_bf16 v20, v75, v75
    v_dot2c_f32_bf16 v5, v76, v21
    v_dot2c_f32_bf16 v7, v76, v76
    v_dot2c_f32_bf16 v6, v77, v21
    v_dot2c_f32_bf16 v20, v77, v77
    v_dot2c_f32_bf16 v5, v78, v21
    v_dot2c_f32_bf16 v7, v78, v78
    v_dot2c_f32_bf16 v6, v79, v21
    v_dot2c_f32_bf16 v20, v79, v79
    v_dot2c_f32_bf16 v5, v80, v21
    v_dot2c_f32_bf16 v7, v80, v80
    v_dot2c_f32_bf16 v6, v81, v21
    v_dot2c_f32_bf16 v20, v81, v81
    v_dot2c_f32_bf16 v5, v82, v21
    v_dot2c_f32_bf16 v7, v82, v82
    v_dot2c_f32_bf16 v6, v83, v21
    v_dot2c_f32_bf16 v20, v83, v83
    v_dot2c_f32_bf16 v5, v84, v21
    v_dot2c_f32_bf16 v7, v84, v84
    v_dot2c_f32_bf16 v6, v85, v21
    v_dot2c_f32_bf16 v20, v85, v85
    v_dot2c_f32_bf16 v5, v86, v21
    v_dot2c_f32_bf16 v7, v86, v86
    v_dot2c_f32_bf16 v6, v87, v21
    v_dot2c_f32_bf16 v20, v87, v87
    v_dot2c_f32_bf16 v32, v104, v21
    v_dot2c_f32_bf16 v33, v108, v21
    v_dot2c_f32_bf16 v34, v112, v21
    v_dot2c_f32_bf16 v32, v105, v21
    v_dot2c_f32_bf16 v33, v109, v21
    v_dot2c_f32_bf16 v34, v113, v21
    v_dot2c_f32_bf16 v32, v106, v21
    v_dot2c_f32_bf16 v33, v110, v21
    v_dot2c_f32_bf16 v34, v114, v21
    v_dot2c_f32_bf16 v32, v107, v21
    v_dot2c_f32_bf16 v33, v111, v21
    v_dot2c_f32_bf16 v34, v115, v21
    s_waitcnt lgkmcnt(7)
    v_mfma_f32_32x32x16_bf16 v[196:211], v[36:39], v[88:91], v[196:211]
    ds_read_b128 v[96:99], v10 offset:49152
    ds_read_b64_tr_b16 v[60:61], v12 offset:43008
    ds_read_b64_tr_b16 v[62:63], v12 offset:43776
    v_mfma_f32_32x32x16_bf16 v[212:227], v[40:43], v[88:91], v[212:227]
    ds_read_b64_tr_b16 v[64:65], v12 offset:43072
    ds_read_b64_tr_b16 v[66:67], v12 offset:43840
    v_mfma_f32_32x32x16_bf16 v[228:243], v[88:91], v[44:47], v[228:243]
    ds_read_b64_tr_b16 v[68:69], v12 offset:43136
    ds_read_b64_tr_b16 v[70:71], v12 offset:43904
    s_waitcnt lgkmcnt(7)
    v_mfma_f32_32x32x16_bf16 v[196:211], v[48:51], v[92:95], v[196:211]
    ds_read_b128 v[100:103], v11 offset:49152
    ds_read_b64_tr_b16 v[36:37], v12 offset:46080
    ds_read_b64_tr_b16 v[38:39], v12 offset:46848
    v_mfma_f32_32x32x16_bf16 v[212:227], v[52:55], v[92:95], v[212:227]
    ds_read_b64_tr_b16 v[40:41], v12 offset:46144
    ds_read_b64_tr_b16 v[42:43], v12 offset:46912
    v_mfma_f32_32x32x16_bf16 v[228:243], v[92:95], v[56:59], v[228:243]
    ds_read_b64_tr_b16 v[44:45], v12 offset:46208
    ds_read_b64_tr_b16 v[46:47], v12 offset:46976
    s_waitcnt lgkmcnt(7)
    v_mfma_f32_32x32x16_bf16 v[196:211], v[60:63], v[96:99], v[196:211]
    ds_read_b64_tr_b16 v[104:105], v3 offset:36864
    ds_read_b64_tr_b16 v[106:107], v3 offset:37632
    ds_read_b64_tr_b16 v[108:109], v3 offset:36928
    v_mfma_f32_32x32x16_bf16 v[212:227], v[64:67], v[96:99], v[212:227]
    ds_read_b64_tr_b16 v[110:111], v3 offset:37696
    ds_read_b64_tr_b16 v[112:113], v3 offset:36992
    v_mfma_f32_32x32x16_bf16 v[228:243], v[96:99], v[68:71], v[228:243]
    ds_read_b64_tr_b16 v[114:115], v3 offset:37760
    s_waitcnt lgkmcnt(6)
    v_mfma_f32_32x32x16_bf16 v[196:211], v[36:39], v[100:103], v[196:211]
    v_mfma_f32_32x32x16_bf16 v[212:227], v[40:43], v[100:103], v[212:227]
    v_mfma_f32_32x32x16_bf16 v[228:243], v[100:103], v[44:47], v[228:243]
    s_waitcnt lgkmcnt(0)
    s_barrier
    ds_read_b128 v[72:75], v8 offset:0
    ds_read_b64_tr_b16 v[48:49], v13 offset:0
    ds_read_b64_tr_b16 v[50:51], v13 offset:768
    ds_read_b64_tr_b16 v[52:53], v13 offset:64
    ds_read_b64_tr_b16 v[54:55], v13 offset:832
    ds_read_b64_tr_b16 v[56:57], v13 offset:128
    ds_read_b64_tr_b16 v[58:59], v13 offset:896
    ds_read_b128 v[76:79], v9 offset:0
    ds_read_b64_tr_b16 v[60:61], v13 offset:3072
    ds_read_b64_tr_b16 v[62:63], v13 offset:3840
    ds_read_b64_tr_b16 v[64:65], v13 offset:3136
    ds_read_b64_tr_b16 v[66:67], v13 offset:3904
    ds_read_b64_tr_b16 v[68:69], v13 offset:3200
    ds_read_b64_tr_b16 v[70:71], v13 offset:3968
    v_dot2c_f32_bf16 v5, v88, v21
    v_dot2c_f32_bf16 v7, v88, v88
    v_dot2c_f32_bf16 v6, v89, v21
    v_dot2c_f32_bf16 v20, v89, v89
    v_dot2c_f32_bf16 v5, v90, v21
    v_dot2c_f32_bf16 v7, v90, v90
    v_dot2c_f32_bf16 v6, v91, v21
    v_dot2c_f32_bf16 v20, v91, v91
    v_dot2c_f32_bf16 v5, v92, v21
    v_dot2c_f32_bf16 v7, v92, v92
    v_dot2c_f32_bf16 v6, v93, v21
    v_dot2c_f32_bf16 v20, v93, v93
    v_dot2c_f32_bf16 v5, v94, v21
    v_dot2c_f32_bf16 v7, v94, v94
    v_dot2c_f32_bf16 v6, v95, v21
    v_dot2c_f32_bf16 v20, v95, v95
    v_dot2c_f32_bf16 v5, v96, v21
    v_dot2c_f32_bf16 v7, v96, v96
    v_dot2c_f32_bf16 v6, v97, v21
    v_dot2c_f32_bf16 v20, v97, v97
    v_dot2c_f32_bf16 v5, v98, v21
    v_dot2c_f32_bf16 v7, v98, v98
    v_dot2c_f32_bf16 v6, v99, v21
    v_dot2c_f32_bf16 v20, v99, v99
    v_dot2c_f32_bf16 v5, v100, v21
    v_dot2c_f32_bf16 v7, v100, v100
    v_dot2c_f32_bf16 v6, v101, v21
    v_dot2c_f32_bf16 v20, v101, v101
    v_dot2c_f32_bf16 v5, v102, v21
    v_dot2c_f32_bf16 v7, v102, v102
    v_dot2c_f32_bf16 v6, v103, v21
    v_dot2c_f32_bf16 v20, v103, v103
    v_dot2c_f32_bf16 v32, v104, v21
    v_dot2c_f32_bf16 v33, v108, v21
    v_dot2c_f32_bf16 v34, v112, v21
    v_dot2c_f32_bf16 v32, v105, v21
    v_dot2c_f32_bf16 v33, v109, v21
    v_dot2c_f32_bf16 v34, v113, v21
    v_dot2c_f32_bf16 v32, v106, v21
    v_dot2c_f32_bf16 v33, v110, v21
    v_dot2c_f32_bf16 v34, v114, v21
    v_dot2c_f32_bf16 v32, v107, v21
    v_dot2c_f32_bf16 v33, v111, v21
    v_dot2c_f32_bf16 v34, v115, v21
    s_waitcnt lgkmcnt(7)
    v_mfma_f32_32x32x16_bf16 v[196:211], v[48:51], v[72:75], v[196:211]
    ds_read_b128 v[80:83], v10 offset:0
    ds_read_b64_tr_b16 v[36:37], v13 offset:6144
    ds_read_b64_tr_b16 v[38:39], v13 offset:6912
    v_mfma_f32_32x32x16_bf16 v[212:227], v[52:55], v[72:75], v[212:227]
    ds_read_b64_tr_b16 v[40:41], v13 offset:6208
    ds_read_b64_tr_b16 v[42:43], v13 offset:6976
    v_mfma_f32_32x32x16_bf16 v[228:243], v[72:75], v[56:59], v[228:243]
    ds_read_b64_tr_b16 v[44:45], v13 offset:6272
    ds_read_b64_tr_b16 v[46:47], v13 offset:7040
    s_waitcnt lgkmcnt(7)
    v_mfma_f32_32x32x16_bf16 v[196:211], v[60:63], v[76:79], v[196:211]
    ds_read_b128 v[84:87], v11 offset:0
    ds_read_b64_tr_b16 v[48:49], v13 offset:9216
    ds_read_b64_tr_b16 v[50:51], v13 offset:9984
    v_mfma_f32_32x32x16_bf16 v[212:227], v[64:67], v[76:79], v[212:227]
    ds_read_b64_tr_b16 v[52:53], v13 offset:9280
    ds_read_b64_tr_b16 v[54:55], v13 offset:10048
    v_mfma_f32_32x32x16_bf16 v[228:243], v[76:79], v[68:71], v[228:243]
    ds_read_b64_tr_b16 v[56:57], v13 offset:9344
    ds_read_b64_tr_b16 v[58:59], v13 offset:10112
    s_waitcnt lgkmcnt(7)
    v_mfma_f32_32x32x16_bf16 v[196:211], v[36:39], v[80:83], v[196:211]
    ds_read_b64_tr_b16 v[104:105], v4 offset:0
    ds_read_b64_tr_b16 v[106:107], v4 offset:768
    ds_read_b64_tr_b16 v[108:109], v4 offset:64
    v_mfma_f32_32x32x16_bf16 v[212:227], v[40:43], v[80:83], v[212:227]
    ds_read_b64_tr_b16 v[110:111], v4 offset:832
    ds_read_b64_tr_b16 v[112:113], v4 offset:128
    v_mfma_f32_32x32x16_bf16 v[228:243], v[80:83], v[44:47], v[228:243]
    ds_read_b64_tr_b16 v[114:115], v4 offset:896
    s_waitcnt lgkmcnt(6)
    v_mfma_f32_32x32x16_bf16 v[196:211], v[48:51], v[84:87], v[196:211]
    v_mfma_f32_32x32x16_bf16 v[212:227], v[52:55], v[84:87], v[212:227]
    v_mfma_f32_32x32x16_bf16 v[228:243], v[84:87], v[56:59], v[228:243]
    s_waitcnt lgkmcnt(0)
    s_barrier
    ds_read_b128 v[88:91], v8 offset:16384
    ds_read_b64_tr_b16 v[60:61], v13 offset:12288
    ds_read_b64_tr_b16 v[62:63], v13 offset:13056
    ds_read_b64_tr_b16 v[64:65], v13 offset:12352
    ds_read_b64_tr_b16 v[66:67], v13 offset:13120
    ds_read_b64_tr_b16 v[68:69], v13 offset:12416
    ds_read_b64_tr_b16 v[70:71], v13 offset:13184
    ds_read_b128 v[92:95], v9 offset:16384
    ds_read_b64_tr_b16 v[36:37], v13 offset:15360
    ds_read_b64_tr_b16 v[38:39], v13 offset:16128
    ds_read_b64_tr_b16 v[40:41], v13 offset:15424
    ds_read_b64_tr_b16 v[42:43], v13 offset:16192
    ds_read_b64_tr_b16 v[44:45], v13 offset:15488
    ds_read_b64_tr_b16 v[46:47], v13 offset:16256
    v_dot2c_f32_bf16 v5, v72, v21
    v_dot2c_f32_bf16 v7, v72, v72
    v_dot2c_f32_bf16 v6, v73, v21
    v_dot2c_f32_bf16 v20, v73, v73
    v_dot2c_f32_bf16 v5, v74, v21
    v_dot2c_f32_bf16 v7, v74, v74
    v_dot2c_f32_bf16 v6, v75, v21
    v_dot2c_f32_bf16 v20, v75, v75
    v_dot2c_f32_bf16 v5, v76, v21
    v_dot2c_f32_bf16 v7, v76, v76
    v_dot2c_f32_bf16 v6, v77, v21
    v_dot2c_f32_bf16 v20, v77, v77
    v_dot2c_f32_bf16 v5, v78, v21
    v_dot2c_f32_bf16 v7, v78, v78
    v_dot2c_f32_bf16 v6, v79, v21
    v_dot2c_f32_bf16 v20, v79, v79
    v_dot2c_f32_bf16 v5, v80, v21
    v_dot2c_f32_bf16 v7, v80, v80
    v_dot2c_f32_bf16 v6, v81, v21
    v_dot2c_f32_bf16 v20, v81, v81
    v_dot2c_f32_bf16 v5, v82, v21
    v_dot2c_f32_bf16 v7, v82, v82
    v_dot2c_f32_bf16 v6, v83, v21
    v_dot2c_f32_bf16 v20, v83, v83
    v_dot2c_f32_bf16 v5, v84, v21
    v_dot2c_f32_bf16 v7, v84, v84
    v_dot2c_f32_bf16 v6, v85, v21
    v_dot2c_f32_bf16 v20, v85, v85
    v_dot2c_f32_bf16 v5, v86, v21
    v_dot2c_f32_bf16 v7, v86, v86
    v_dot2c_f32_bf16 v6, v87, v21
    v_dot2c_f32_bf16 v20, v87, v87
    v_dot2c_f32_bf16 v32, v104, v21
    v_dot2c_f32_bf16 v33, v108, v21
    v_dot2c_f32_bf16 v34, v112, v21
    v_dot2c_f32_bf16 v32, v105, v21
    v_dot2c_f32_bf16 v33, v109, v21
    v_dot2c_f32_bf16 v34, v113, v21
    v_dot2c_f32_bf16 v32, v106, v21
    v_dot2c_f32_bf16 v33, v110, v21
    v_dot2c_f32_bf16 v34, v114, v21
    v_dot2c_f32_bf16 v32, v107, v21
    v_dot2c_f32_bf16 v33, v111, v21
    v_dot2c_f32_bf16 v34, v115, v21
    s_waitcnt lgkmcnt(7)
    v_mfma_f32_32x32x16_bf16 v[196:211], v[60:63], v[88:91], v[196:211]
    ds_read_b128 v[96:99], v10 offset:16384
    ds_read_b64_tr_b16 v[48:49], v13 offset:18432
    ds_read_b64_tr_b16 v[50:51], v13 offset:19200
    v_mfma_f32_32x32x16_bf16 v[212:227], v[64:67], v[88:91], v[212:227]
    ds_read_b64_tr_b16 v[52:53], v13 offset:18496
    ds_read_b64_tr_b16 v[54:55], v13 offset:19264
    v_mfma_f32_32x32x16_bf16 v[228:243], v[88:91], v[68:71], v[228:243]
    ds_read_b64_tr_b16 v[56:57], v13 offset:18560
    ds_read_b64_tr_b16 v[58:59], v13 offset:19328
    s_waitcnt lgkmcnt(7)
    v_mfma_f32_32x32x16_bf16 v[196:211], v[36:39], v[92:95], v[196:211]
    ds_read_b128 v[100:103], v11 offset:16384
    ds_read_b64_tr_b16 v[60:61], v13 offset:21504
    ds_read_b64_tr_b16 v[62:63], v13 offset:22272
    v_mfma_f32_32x32x16_bf16 v[212:227], v[40:43], v[92:95], v[212:227]
    ds_read_b64_tr_b16 v[64:65], v13 offset:21568
    ds_read_b64_tr_b16 v[66:67], v13 offset:22336
    v_mfma_f32_32x32x16_bf16 v[228:243], v[92:95], v[44:47], v[228:243]
    ds_read_b64_tr_b16 v[68:69], v13 offset:21632
    ds_read_b64_tr_b16 v[70:71], v13 offset:22400
    s_waitcnt lgkmcnt(7)
    v_mfma_f32_32x32x16_bf16 v[196:211], v[48:51], v[96:99], v[196:211]
    ds_read_b64_tr_b16 v[104:105], v4 offset:12288
    ds_read_b64_tr_b16 v[106:107], v4 offset:13056
    ds_read_b64_tr_b16 v[108:109], v4 offset:12352
    v_mfma_f32_32x32x16_bf16 v[212:227], v[52:55], v[96:99], v[212:227]
    ds_read_b64_tr_b16 v[110:111], v4 offset:13120
    ds_read_b64_tr_b16 v[112:113], v4 offset:12416
    v_mfma_f32_32x32x16_bf16 v[228:243], v[96:99], v[56:59], v[228:243]
    ds_read_b64_tr_b16 v[114:115], v4 offset:13184
    s_waitcnt lgkmcnt(6)
    v_mfma_f32_32x32x16_bf16 v[196:211], v[60:63], v[100:103], v[196:211]
    v_mfma_f32_32x32x16_bf16 v[212:227], v[64:67], v[100:103], v[212:227]
    v_mfma_f32_32x32x16_bf16 v[228:243], v[100:103], v[68:71], v[228:243]
    s_waitcnt lgkmcnt(0)
    s_barrier
    ds_read_b128 v[72:75], v8 offset:32768
    ds_read_b128 v[76:79], v9 offset:32768
    ds_read_b128 v[80:83], v10 offset:32768
    ds_read_b128 v[84:87], v11 offset:32768
    ds_read_b64_tr_b16 v[36:37], v13 offset:24576
    ds_read_b64_tr_b16 v[38:39], v13 offset:25344
    ds_read_b64_tr_b16 v[40:41], v13 offset:24640
    ds_read_b64_tr_b16 v[42:43], v13 offset:25408
    ds_read_b64_tr_b16 v[44:45], v13 offset:24704
    ds_read_b64_tr_b16 v[46:47], v13 offset:25472
    v_dot2c_f32_bf16 v5, v88, v21
    v_dot2c_f32_bf16 v7, v88, v88
    v_dot2c_f32_bf16 v6, v89, v21
    v_dot2c_f32_bf16 v20, v89, v89
    v_dot2c_f32_bf16 v5, v90, v21
    v_dot2c_f32_bf16 v7, v90, v90
    v_dot2c_f32_bf16 v6, v91, v21
    v_dot2c_f32_bf16 v20, v91, v91
    v_dot2c_f32_bf16 v5, v92, v21
    v_dot2c_f32_bf16 v7, v92, v92
    v_dot2c_f32_bf16 v6, v93, v21
    v_dot2c_f32_bf16 v20, v93, v93
    v_dot2c_f32_bf16 v5, v94, v21
    v_dot2c_f32_bf16 v7, v94, v94
    v_dot2c_f32_bf16 v6, v95, v21
    v_dot2c_f32_bf16 v20, v95, v95
    v_dot2c_f32_bf16 v5, v96, v21
    v_dot2c_f32_bf16 v7, v96, v96
    v_dot2c_f32_bf16 v6, v97, v21
    v_dot2c_f32_bf16 v20, v97, v97
    v_dot2c_f32_bf16 v5, v98, v21
    v_dot2c_f32_bf16 v7, v98, v98
    v_dot2c_f32_bf16 v6, v99, v21
    v_dot2c_f32_bf16 v20, v99, v99
    v_dot2c_f32_bf16 v5, v100, v21
    v_dot2c_f32_bf16 v7, v100, v100
    v_dot2c_f32_bf16 v6, v101, v21
    v_dot2c_f32_bf16 v20, v101, v101
    v_dot2c_f32_bf16 v5, v102, v21
    v_dot2c_f32_bf16 v7, v102, v102
    v_dot2c_f32_bf16 v6, v103, v21
    v_dot2c_f32_bf16 v20, v103, v103
    v_dot2c_f32_bf16 v32, v104, v21
    v_dot2c_f32_bf16 v33, v108, v21
    v_dot2c_f32_bf16 v34, v112, v21
    v_dot2c_f32_bf16 v32, v105, v21
    v_dot2c_f32_bf16 v33, v109, v21
    v_dot2c_f32_bf16 v34, v113, v21
    v_dot2c_f32_bf16 v32, v106, v21
    v_dot2c_f32_bf16 v33, v110, v21
    v_dot2c_f32_bf16 v34, v114, v21
    v_dot2c_f32_bf16 v32, v107, v21
    v_dot2c_f32_bf16 v33, v111, v21
    v_dot2c_f32_bf16 v34, v115, v21
    s_waitcnt lgkmcnt(6)
    ds_read_b64_tr_b16 v[104:105], v4 offset:24576
    ds_read_b64_tr_b16 v[106:107], v4 offset:25344
    ds_read_b64_tr_b16 v[108:109], v4 offset:24640
    ds_read_b64_tr_b16 v[110:111], v4 offset:25408
    ds_read_b64_tr_b16 v[112:113], v4 offset:24704
    ds_read_b64_tr_b16 v[114:115], v4 offset:25472
    v_dot2c_f32_bf16 v5, v72, v21
    v_dot2c_f32_bf16 v7, v72, v72
    v_dot2c_f32_bf16 v6, v73, v21
    v_dot2c_f32_bf16 v20, v73, v73
    v_dot2c_f32_bf16 v5, v74, v21
    v_dot2c_f32_bf16 v7, v74, v74
    v_dot2c_f32_bf16 v6, v75, v21
    v_dot2c_f32_bf16 v20, v75, v75
    v_dot2c_f32_bf16 v5, v76, v21
    v_dot2c_f32_bf16 v7, v76, v76
    v_dot2c_f32_bf16 v6, v77, v21
    v_dot2c_f32_bf16 v20, v77, v77
    v_dot2c_f32_bf16 v5, v78, v21
    v_dot2c_f32_bf16 v7, v78, v78
    v_dot2c_f32_bf16 v6, v79, v21
    v_dot2c_f32_bf16 v20, v79, v79
    v_dot2c_f32_bf16 v5, v80, v21
    v_dot2c_f32_bf16 v7, v80, v80
    v_dot2c_f32_bf16 v6, v81, v21
    v_dot2c_f32_bf16 v20, v81, v81
    v_dot2c_f32_bf16 v5, v82, v21
    v_dot2c_f32_bf16 v7, v82, v82
    v_dot2c_f32_bf16 v6, v83, v21
    v_dot2c_f32_bf16 v20, v83, v83
    v_dot2c_f32_bf16 v5, v84, v21
    v_dot2c_f32_bf16 v7, v84, v84
    v_dot2c_f32_bf16 v6, v85, v21
    v_dot2c_f32_bf16 v20, v85, v85
    v_dot2c_f32_bf16 v5, v86, v21
    v_dot2c_f32_bf16 v7, v86, v86
    v_dot2c_f32_bf16 v6, v87, v21
    v_dot2c_f32_bf16 v20, v87, v87
    s_waitcnt lgkmcnt(0)
    v_dot2c_f32_bf16 v32, v104, v21
    v_dot2c_f32_bf16 v33, v108, v21
    v_dot2c_f32_bf16 v34, v112, v21
    v_dot2c_f32_bf16 v32, v105, v21
    v_dot2c_f32_bf16 v33, v109, v21
    v_dot2c_f32_bf16 v34, v113, v21
    v_dot2c_f32_bf16 v32, v106, v21
    v_dot2c_f32_bf16 v33, v110, v21
    v_dot2c_f32_bf16 v34, v114, v21
    v_dot2c_f32_bf16 v32, v107, v21
    v_dot2c_f32_bf16 v33, v111, v21
    v_dot2c_f32_bf16 v34, v115, v21
    ds_read_b64_tr_b16 v[48:49], v13 offset:27648
    ds_read_b64_tr_b16 v[50:51], v13 offset:28416
    ds_read_b64_tr_b16 v[52:53], v13 offset:27712
    ds_read_b64_tr_b16 v[54:55], v13 offset:28480
    ds_read_b64_tr_b16 v[56:57], v13 offset:27776
    ds_read_b64_tr_b16 v[58:59], v13 offset:28544
    v_mfma_f32_32x32x16_bf16 v[196:211], v[36:39], v[72:75], v[196:211]
    ds_read_b64_tr_b16 v[60:61], v13 offset:30720
    ds_read_b64_tr_b16 v[62:63], v13 offset:31488
    v_add_f32 v5, v5, v6
    v_add_f32 v7, v7, v20
    v_mov_b32 v104, v32
    v_mov_b32 v105, v33
    v_mov_b32 v106, v34
    v_mfma_f32_32x32x16_bf16 v[212:227], v[40:43], v[72:75], v[212:227]
    ds_read_b64_tr_b16 v[64:65], v13 offset:30784
    ds_read_b64_tr_b16 v[66:67], v13 offset:31552
    v_mov_b32 v24, v5
    v_mov_b32 v25, v7
    v_permlane32_swap_b32 v32, v104
    v_permlane32_swap_b32 v33, v105
    v_permlane32_swap_b32 v34, v106
    v_mfma_f32_32x32x16_bf16 v[228:243], v[72:75], v[44:47], v[228:243]
    ds_read_b64_tr_b16 v[68:69], v13 offset:30848
    ds_read_b64_tr_b16 v[70:71], v13 offset:31616
    v_permlane32_swap_b32 v5, v24
    v_permlane32_swap_b32 v7, v25
    v_add_f32 v32, v32, v104
    v_add_f32 v33, v33, v105
    v_add_f32 v34, v34, v106
    s_waitcnt lgkmcnt(6)
    v_mfma_f32_32x32x16_bf16 v[196:211], v[48:51], v[76:79], v[196:211]
    ds_read_b64_tr_b16 v[36:37], v13 offset:33792
    ds_read_b64_tr_b16 v[38:39], v13 offset:34560
    v_add_f32 v5, v5, v24
    v_add_f32 v7, v7, v25
    v_and_b32 v104, 0xffff0000, v32
    v_and_b32 v105, 0xffff0000, v33
    v_and_b32 v106, 0xffff0000, v34
    v_mfma_f32_32x32x16_bf16 v[212:227], v[52:55], v[76:79], v[212:227]
    ds_read_b64_tr_b16 v[40:41], v13 offset:33856
    ds_read_b64_tr_b16 v[42:43], v13 offset:34624
    v_mul_f32 v5, 0x3b124925, v5
    v_mul_f32 v7, 0x3b124925, v7
    v_sub_f32 v32, v32, v104
    v_sub_f32 v33, v33, v105
    v_sub_f32 v34, v34, v106
    v_mfma_f32_32x32x16_bf16 v[228:243], v[76:79], v[56:59], v[228:243]
    ds_read_b64_tr_b16 v[44:45], v13 offset:33920
    ds_read_b64_tr_b16 v[46:47], v13 offset:34688
    v_fma_f32 v7, -v5, v5, v7
    v_sub_f32 v5, 0, v5
    v_cvt_pk_bf16_f32 v32, v104, v32
    v_cvt_pk_bf16_f32 v33, v105, v33
    v_cvt_pk_bf16_f32 v34, v106, v34
    s_waitcnt lgkmcnt(6)
    v_mfma_f32_32x32x16_bf16 v[196:211], v[60:63], v[80:83], v[196:211]
    v_max_f32 v7, 0, v7
    v_and_b32 v24, 0xffff0000, v5
    ds_write_b32 v17, v32 offset:0
    ds_write_b32 v17, v33 offset:512
    ds_write_b32 v17, v34 offset:1024
    v_mfma_f32_32x32x16_bf16 v[212:227], v[64:67], v[80:83], v[212:227]
    v_add_f32 v7, 0x3727c5ac, v7
    v_sub_f32 v25, v5, v24
    v_rsq_f32 v35, v7
    v_cvt_pk_bf16_f32 v100, v24, v24
    ds_write_b32 v18, v35
    v_mfma_f32_32x32x16_bf16 v[228:243], v[80:83], v[68:71], v[228:243]
    s_mov_b32 exec_lo, 0
    v_cvt_pk_bf16_f32 v100, v25, 0
    s_mov_b32 exec_lo, -1
    v_mul_f32 v244, 0x3e8b97f6, v35
    v_mov_b32 v101, v100
    s_waitcnt lgkmcnt(0)
    s_barrier
    ds_read_b128 v[92:95], v16 offset:512
    ds_read_b128 v[96:99], v16 offset:1024
    ds_read_b128 v[88:91], v16 offset:0
    ds_read_b64 v[28:29], v31
    ds_read_b128 v[48:51], v19 offset:0
    ds_read_b128 v[52:55], v19 offset:32
    ds_read_b128 v[56:59], v19 offset:64
    ds_read_b128 v[60:63], v19 offset:96
    v_mfma_f32_32x32x16_bf16 v[212:227], v[40:43], v[84:87], v[212:227]
    v_mov_b32 v102, v100
    v_mov_b32 v103, v100
    v_mfma_f32_32x32x16_bf16 v[228:243], v[84:87], v[44:47], v[228:243]
    v_mfma_f32_32x32x16_bf16 v[196:211], v[36:39], v[84:87], v[196:211]
    s_waitcnt lgkmcnt(7)
    v_mfma_f32_32x32x16_bf16 v[212:227], v[92:95], v[100:103], v[212:227]
    s_waitcnt lgkmcnt(6)
    v_mfma_f32_32x32x16_bf16 v[228:243], v[100:103], v[96:99], v[228:243]
    s_waitcnt lgkmcnt(5)
    v_mfma_f32_32x32x16_bf16 v[196:211], v[88:91], v[100:103], v[196:211]
    s_waitcnt lgkmcnt(0)
    v_readfirstlane_b32 s60, v28
    v_readfirstlane_b32 s59, v29
    s_nop 6
    v_mul_f32 v212, v35, v212
    v_mul_f32 v213, v35, v213
    v_mul_f32 v214, v35, v214
    v_mul_f32 v215, v35, v215
    v_mul_f32 v216, v35, v216
    v_mul_f32 v217, v35, v217
    v_mul_f32 v218, v35, v218
    v_mul_f32 v219, v35, v219
    v_mul_f32 v220, v35, v220
    v_mul_f32 v221, v35, v221
    v_mul_f32 v222, v35, v222
    v_mul_f32 v223, v35, v223
    v_mul_f32 v224, v35, v224
    v_mul_f32 v225, v35, v225
    v_mul_f32 v226, v35, v226
    v_mul_f32 v227, v35, v227
    v_cvt_pk_bf16_f32 v180, v212, v213
    v_cvt_pk_bf16_f32 v181, v214, v215
    v_cvt_pk_bf16_f32 v182, v216, v217
    v_cvt_pk_bf16_f32 v183, v218, v219
    v_cvt_pk_bf16_f32 v184, v220, v221
    v_cvt_pk_bf16_f32 v185, v222, v223
    v_cvt_pk_bf16_f32 v186, v224, v225
    v_cvt_pk_bf16_f32 v187, v226, v227
    s_mov_b32 exec_lo, 0
    v_mov_b32 v186, 0x3f803f80
    v_mov_b32 v187, 0
    s_mov_b32 exec_lo, -1
    buffer_store_dwordx4 v[180:183], v14, s[16:19], s71 offen sc1
    buffer_store_dwordx4 v[184:187], v14, s[16:19], s71 offen offset:1024 sc1
    ds_write_b128 v245, v[180:183] offset:8192
    ds_write_b128 v245, v[184:187] offset:9216
    v_mul_f32 v228, v48, v228
    v_mul_f32 v229, v49, v229
    v_mul_f32 v230, v50, v230
    v_mul_f32 v231, v51, v231
    v_mul_f32 v232, v52, v232
    v_mul_f32 v233, v53, v233
    v_mul_f32 v234, v54, v234
    v_mul_f32 v235, v55, v235
    v_mul_f32 v236, v56, v236
    v_mul_f32 v237, v57, v237
    v_mul_f32 v238, v58, v238
    v_mul_f32 v239, v59, v239
    v_mul_f32 v240, v60, v240
    v_mul_f32 v241, v61, v241
    v_mul_f32 v242, v62, v242
    v_mul_f32 v243, v63, v243
    v_cvt_pk_bf16_f32 v188, v228, v229
    v_cvt_pk_bf16_f32 v189, v230, v231
    v_cvt_pk_bf16_f32 v190, v232, v233
    v_cvt_pk_bf16_f32 v191, v234, v235
    v_cvt_pk_bf16_f32 v192, v236, v237
    v_cvt_pk_bf16_f32 v193, v238, v239
    v_cvt_pk_bf16_f32 v194, v240, v241
    v_cvt_pk_bf16_f32 v195, v242, v243
    s_mov_b32 exec_lo, 0xf0000000
    s_mov_b32 exec_hi, 0xf0000000
    v_mov_b32 v188, v15
    v_mov_b32 v189, v15
    v_mov_b32 v190, v15
    v_mov_b32 v191, v15
    v_mov_b32 v192, v15
    v_mov_b32 v193, v15
    v_mov_b32 v194, v15
    v_mov_b32 v195, v15
    s_mov_b64 exec, -1
    buffer_store_dwordx4 v[188:191], v2, s[16:19], s73 offen sc1
    buffer_store_dwordx4 v[192:195], v2, s[16:19], s73 offen offset:1024 sc1
    v_mul_f32 v196, v244, v196
    v_mul_f32 v197, v244, v197
    v_mul_f32 v198, v244, v198
    v_mul_f32 v199, v244, v199
    v_mul_f32 v200, v244, v200
    v_mul_f32 v201, v244, v201
    v_mul_f32 v202, v244, v202
    v_mul_f32 v203, v244, v203
    v_mul_f32 v204, v244, v204
    v_mul_f32 v205, v244, v205
    v_mul_f32 v206, v244, v206
    v_mul_f32 v207, v244, v207
    v_mul_f32 v208, v244, v208
    v_mul_f32 v209, v244, v209
    v_mul_f32 v210, v244, v210
    v_mul_f32 v211, v244, v211
    v_cvt_pk_bf16_f32 v196, v196, v197
    v_cvt_pk_bf16_f32 v197, v198, v199
    v_cvt_pk_bf16_f32 v198, v200, v201
    v_cvt_pk_bf16_f32 v199, v202, v203
    v_cvt_pk_bf16_f32 v200, v204, v205
    v_cvt_pk_bf16_f32 v201, v206, v207
    v_cvt_pk_bf16_f32 v202, v208, v209
    v_cvt_pk_bf16_f32 v203, v210, v211
    s_mov_b32 exec_lo, 0
    v_mov_b32 v202, 0
    v_mov_b32 v203, 0
    s_mov_b32 exec_lo, -1
    ds_write_b128 v245, v[196:199] offset:0
    ds_write_b128 v245, v[200:203] offset:1024
    s_waitcnt lgkmcnt(0)
    s_barrier
    s_lshl_b32 s65, s76, 11
    v_add_u32 v4, s65, v2
    ds_read_b128 v[20:23], v4 offset:0
    ds_read_b128 v[24:27], v4 offset:1024
    s_lshl_b32 s65, s77, 11
    v_add_u32 v4, s65, v2
    ds_read_b128 v[28:31], v4 offset:0
    ds_read_b128 v[32:35], v4 offset:1024
    s_lshl_b32 s65, s78, 11
    v_add_u32 v4, s65, v2
    ds_read_b128 v[36:39], v4 offset:0
    ds_read_b128 v[40:43], v4 offset:1024
    s_lshl_b32 s65, s79, 11
    v_add_u32 v4, s65, v2
    ds_read_b128 v[44:47], v4 offset:0
    ds_read_b128 v[48:51], v4 offset:1024
    ds_read_b128 v[228:231], v2 offset:8192
    ds_read_b128 v[232:235], v2 offset:9216
    v_permlane32_swap_b32 v188, v190
    v_permlane32_swap_b32 v189, v191
    v_permlane32_swap_b32 v192, v194
    v_permlane32_swap_b32 v193, v195
    v_mov_b32 v3, 0xdddddddd
    s_mov_b32 s33, 0
    s_waitcnt lgkmcnt(0)
    v_mfma_f32_32x32x16_bf16 v[52:67], v[228:231], v[20:23], 0
    v_mfma_f32_32x32x16_bf16 v[52:67], v[232:235], v[24:27], v[52:67]
    v_mfma_f32_32x32x16_bf16 v[68:83], v[228:231], v[28:31], 0
    v_mfma_f32_32x32x16_bf16 v[68:83], v[232:235], v[32:35], v[68:83]
    v_mfma_f32_32x32x16_bf16 v[84:99], v[228:231], v[36:39], 0
    v_mfma_f32_32x32x16_bf16 v[84:99], v[232:235], v[40:43], v[84:99]
    v_mfma_f32_32x32x16_bf16 v[100:115], v[228:231], v[44:47], 0
    v_mfma_f32_32x32x16_bf16 v[100:115], v[232:235], v[48:51], v[100:115]
    s_lshl_b32 s64, s21, 6
    s_add_u32 s64, s64, s3
    v_and_b32 v10, 15, v1
    v_lshl_add_u32 v10, v10, 2, s64
    v_lshlrev_b32 v10, 2, v10
    v_min_u32 v8, 15, v1
    s_mov_b32 s65, 0
    v_add_u32 v8, s65, v8
    v_and_b32 v8, 15, v8
    v_lshl_add_u32 v8, v8, 2, s64
    v_lshlrev_b32 v8, 2, v8
    s_mov_b32 s64, 0x1600000
    s_mul_i32 s65, s76, 12288
    s_add_u32 s65, s65, 0
    v_add_u32 v12, s65, v2
    s_mul_i32 s65, s77, 12288
    s_add_u32 s65, s65, 4096
    v_add_u32 v13, s65, v2
    s_mul_i32 s65, s78, 12288
    s_add_u32 s65, s65, 8192
    v_add_u32 v14, s65, v2
    v_max_f32 v16, v52, v53
    v_max_f32 v17, v68, v69
    v_max_f32 v18, v84, v85
    v_max_f32 v19, v100, v101
    v_max3_f32 v16, v16, v54, v55
    v_max3_f32 v17, v17, v70, v71
    v_max3_f32 v18, v18, v86, v87
    v_max3_f32 v19, v19, v102, v103
    v_max3_f32 v16, v16, v56, v57
    v_max3_f32 v17, v17, v72, v73
    v_max3_f32 v18, v18, v88, v89
    v_max3_f32 v19, v19, v104, v105
    v_max3_f32 v16, v16, v58, v59
    v_max3_f32 v17, v17, v74, v75
    v_max3_f32 v18, v18, v90, v91
    v_max3_f32 v19, v19, v106, v107
    v_max3_f32 v16, v16, v60, v61
    v_max3_f32 v17, v17, v76, v77
    v_max3_f32 v18, v18, v92, v93
    v_max3_f32 v19, v19, v108, v109
    v_max3_f32 v16, v16, v62, v63
    v_max3_f32 v17, v17, v78, v79
    v_max3_f32 v18, v18, v94, v95
    v_max3_f32 v19, v19, v110, v111
    v_max3_f32 v16, v16, v64, v65
    v_max3_f32 v17, v17, v80, v81
    v_max3_f32 v18, v18, v96, v97
    v_max3_f32 v19, v19, v112, v113
    v_max3_f32 v16, v16, v66, v67
    v_max3_f32 v17, v17, v82, v83
    v_max3_f32 v18, v18, v98, v99
    v_max3_f32 v19, v19, v114, v115
    v_mov_b32 v4, v16
    v_mov_b32 v5, v17
    v_mov_b32 v6, v18
    v_mov_b32 v7, v19
    s_nop 0
    v_permlane32_swap_b32 v16, v4
    v_permlane32_swap_b32 v17, v5
    v_permlane32_swap_b32 v18, v6
    v_permlane32_swap_b32 v19, v7
    v_max_f32 v16, v16, v4
    v_max_f32 v17, v17, v5
    v_max_f32 v18, v18, v6
    v_max_f32 v19, v19, v7
    v_and_b32 v4, 0xffff0000, v16
    v_and_b32 v5, 0xffff0000, v17
    v_and_b32 v6, 0xffff0000, v18
    v_and_b32 v7, 0xffff0000, v19
    v_sub_f32 v16, v4, v16
    v_sub_f32 v17, v5, v17
    v_sub_f32 v18, v6, v18
    v_sub_f32 v19, v7, v19
    v_cvt_pk_bf16_f32 v4, -v4, v16
    v_cvt_pk_bf16_f32 v5, -v5, v17
    v_cvt_pk_bf16_f32 v6, -v6, v18
    v_cvt_pk_bf16_f32 v7, -v7, v19
    s_mov_b32 exec_lo, 0
    v_mov_b32 v26, v4
    v_mov_b32 v34, v5
    v_mov_b32 v42, v6
    v_mov_b32 v50, v7
    s_mov_b32 exec_lo, -1
    s_waitcnt vmcnt(0)
    v_mov_b32 v9, s60
    s_mov_b64 exec, 1
    s_cmp_eq_u32 s59, 0
    s_cbranch_scc1 L_slow0
    buffer_store_dword v9, off, s[16:19], s70
L_back0:
    s_mov_b64 exec, -1
L_setm:
    v_mfma_f32_32x32x16_bf16 v[52:67], v[180:183], v[20:23], 0
    v_mfma_f32_32x32x16_bf16 v[52:67], v[184:187], v[24:27], v[52:67]
    s_nop 7
    s_nop 2
.p2align 3
    v_mfma_f32_32x32x16_bf16 v[68:83], v[180:183], v[28:31], 0
    v_exp_f32 v52, v52
    v_exp_f32 v53, v53
    v_exp_f32 v54, v54
    v_exp_f32 v55, v55
    v_mfma_f32_32x32x16_bf16 v[68:83], v[184:187], v[32:35], v[68:83]
    v_exp_f32 v56, v56
    v_exp_f32 v57, v57
    v_exp_f32 v58, v58
    v_exp_f32 v59, v59
    v_exp_f32 v60, v60
    v_exp_f32 v61, v61
    v_exp_f32 v62, v62
    v_exp_f32 v63, v63
    v_smfmac_f32_32x32x32_bf16 v[116:131], v[188:191], v[52:59], v3
    v_exp_f32 v64, v64
    v_exp_f32 v65, v65
    v_exp_f32 v66, v66
    v_exp_f32 v67, v67
    v_mfma_f32_32x32x16_bf16 v[84:99], v[180:183], v[36:39], 0
    v_exp_f32 v68, v68
    v_exp_f32 v69, v69
    v_exp_f32 v70, v70
    v_exp_f32 v71, v71
    v_mfma_f32_32x32x16_bf16 v[84:99], v[184:187], v[40:43], v[84:99]
    v_exp_f32 v72, v72
    v_exp_f32 v73, v73
    v_exp_f32 v74, v74
    v_exp_f32 v75, v75
    v_smfmac_f32_32x32x32_bf16 v[116:131], v[192:195], v[60:67], v3
    v_exp_f32 v76, v76
    v_exp_f32 v77, v77
    v_exp_f32 v78, v78
    v_exp_f32 v79, v79
    v_smfmac_f32_32x32x32_bf16 v[132:147], v[188:191], v[68:75], v3
    v_exp_f32 v80, v80
    v_exp_f32 v81, v81
    v_exp_f32 v82, v82
    v_exp_f32 v83, v83
    s_cmp_lg_u32 s33, 0
    s_cbranch_scc1 L_nopoll1
    s_mov_b32 s34, 100000
poll_1:
    buffer_load_dword v9, v8, s[16:19], s64 offen sc1
    s_sub_u32 s34, s34, 1
    s_cbranch_scc1 polle_2
    s_waitcnt vmcnt(0)
    v_cmp_ne_u32 vcc, s60, v9
    s_cbranch_vccnz poll_1
polle_2:
    s_waitcnt vmcnt(0)
L_nopoll1:
    global_load_dwordx4 v[196:199], v2, s[36:37]
    global_load_dwordx4 v[200:203], v2, s[36:37] offset:1024
    global_load_dwordx4 v[204:207], v2, s[36:37] offset:2048
    global_load_dwordx4 v[208:211], v2, s[36:37] offset:3072
    s_cmp_lg_u32 s33, 0
    s_cbranch_scc1 L_nogo
    s_barrier
L_nogo:
    v_mfma_f32_32x32x16_bf16 v[100:115], v[180:183], v[44:47], 0
    v_exp_f32 v84, v84
    v_exp_f32 v85, v85
    v_exp_f32 v86, v86
    v_exp_f32 v87, v87
    v_mfma_f32_32x32x16_bf16 v[100:115], v[184:187], v[48:51], v[100:115]
    v_exp_f32 v88, v88
    v_exp_f32 v89, v89
    v_exp_f32 v90, v90
    v_exp_f32 v91, v91
    v_smfmac_f32_32x32x32_bf16 v[132:147], v[192:195], v[76:83], v3
    global_load_dwordx4 v[212:215], v2, s[38:39]
    global_load_dwordx4 v[216:219], v2, s[38:39] offset:1024
    global_load_dwordx4 v[220:223], v2, s[38:39] offset:2048
    global_load_dwordx4 v[224:227], v2, s[38:39] offset:3072
    v_exp_f32 v92, v92
    v_exp_f32 v93, v93
    v_exp_f32 v94, v94
    v_exp_f32 v95, v95
    v_smfmac_f32_32x32x32_bf16 v[148:163], v[188:191], v[84:91], v3
    v_exp_f32 v96, v96
    v_exp_f32 v97, v97
    v_exp_f32 v98, v98
    v_exp_f32 v99, v99
    s_waitcnt vmcnt(6)
    v_mfma_f32_32x32x16_bf16 v[52:67], v[196:199], v[20:23], 0
    v_exp_f32 v100, v100
    v_exp_f32 v101, v101
    v_exp_f32 v102, v102
    v_exp_f32 v103, v103
    v_mfma_f32_32x32x16_bf16 v[52:67], v[200:203], v[24:27], v[52:67]
    v_exp_f32 v104, v104
    v_exp_f32 v105, v105
    v_exp_f32 v106, v106
    v_exp_f32 v107, v107
    v_smfmac_f32_32x32x32_bf16 v[148:163], v[192:195], v[92:99], v3
    global_load_dwordx4 v[228:231], v2, s[40:41]
    global_load_dwordx4 v[232:235], v2, s[40:41] offset:1024
    global_load_dwordx4 v[236:239], v2, s[40:41] offset:2048
    global_load_dwordx4 v[240:243], v2, s[40:41] offset:3072
    v_exp_f32 v108, v108
    v_exp_f32 v109, v109
    v_exp_f32 v110, v110
    v_exp_f32 v111, v111
    v_smfmac_f32_32x32x32_bf16 v[164:179], v[188:191], v[100:107], v3
    v_exp_f32 v112, v112
    v_exp_f32 v113, v113
    v_exp_f32 v114, v114
    v_exp_f32 v115, v115
    s_waitcnt vmcnt(8)
    v_mfma_f32_32x32x16_bf16 v[68:83], v[196:199], v[28:31], 0
    v_exp_f32 v52, v52
    v_exp_f32 v53, v53
    v_exp_f32 v54, v54
    v_exp_f32 v55, v55
    v_mfma_f32_32x32x16_bf16 v[68:83], v[200:203], v[32:35], v[68:83]
    v_exp_f32 v56, v56
    v_exp_f32 v57, v57
    v_exp_f32 v58, v58
    v_exp_f32 v59, v59
    v_smfmac_f32_32x32x32_bf16 v[164:179], v[192:195], v[108:115], v3
    global_load_dwordx4 v[180:183], v2, s[42:43]
    global_load_dwordx4 v[184:187], v2, s[42:43] offset:1024
    global_load_dwordx4 v[188:191], v2, s[42:43] offset:2048
    global_load_dwordx4 v[192:195], v2, s[42:43] offset:3072
    v_exp_f32 v60, v60
    v_exp_f32 v61, v61
    v_exp_f32 v62, v62
    v_exp_f32 v63, v63
    v_smfmac_f32_32x32x32_bf16 v[116:131], v[204:207], v[52:59], v3
    v_exp_f32 v64, v64
    v_exp_f32 v65, v65
    v_exp_f32 v66, v66
    v_exp_f32 v67, v67
    v_mfma_f32_32x32x16_bf16 v[84:99], v[196:199], v[36:39], 0
    v_exp_f32 v68, v68
    v_exp_f32 v69, v69
    v_exp_f32 v70, v70
    v_exp_f32 v71, v71
    v_mfma_f32_32x32x16_bf16 v[84:99], v[200:203], v[40:43], v[84:99]
    v_exp_f32 v72, v72
    v_exp_f32 v73, v73
    v_exp_f32 v74, v74
    v_exp_f32 v75, v75
    v_smfmac_f32_32x32x32_bf16 v[116:131], v[208:211], v[60:67], v3
    v_exp_f32 v76, v76
    v_exp_f32 v77, v77
    v_exp_f32 v78, v78
    v_exp_f32 v79, v79
    v_smfmac_f32_32x32x32_bf16 v[132:147], v[204:207], v[68:75], v3
    v_exp_f32 v80, v80
    v_exp_f32 v81, v81
    v_exp_f32 v82, v82
    v_exp_f32 v83, v83
    v_mfma_f32_32x32x16_bf16 v[100:115], v[196:199], v[44:47], 0
    v_exp_f32 v84, v84
    v_exp_f32 v85, v85
    v_exp_f32 v86, v86
    v_exp_f32 v87, v87
    v_mfma_f32_32x32x16_bf16 v[100:115], v[200:203], v[48:51], v[100:115]
    v_exp_f32 v88, v88
    v_exp_f32 v89, v89
    v_exp_f32 v90, v90
    v_exp_f32 v91, v91
    v_smfmac_f32_32x32x32_bf16 v[132:147], v[208:211], v[76:83], v3
    v_exp_f32 v92, v92
    v_exp_f32 v93, v93
    v_exp_f32 v94, v94
    v_exp_f32 v95, v95
    v_smfmac_f32_32x32x32_bf16 v[148:163], v[204:207], v[84:91], v3
    v_exp_f32 v96, v96
    v_exp_f32 v97, v97
    v_exp_f32 v98, v98
    v_exp_f32 v99, v99
    s_waitcnt vmcnt(8)
    v_mfma_f32_32x32x16_bf16 v[52:67], v[212:215], v[20:23], 0
    v_exp_f32 v100, v100
    v_exp_f32 v101, v101
    v_exp_f32 v102, v102
    v_exp_f32 v103, v103
    v_mfma_f32_32x32x16_bf16 v[52:67], v[216:219], v[24:27], v[52:67]
    v_exp_f32 v104, v104
    v_exp_f32 v105, v105
    v_exp_f32 v106, v106
    v_exp_f32 v107, v107
    v_smfmac_f32_32x32x32_bf16 v[148:163], v[208:211], v[92:99], v3
    v_exp_f32 v108, v108
    v_exp_f32 v109, v109
    v_exp_f32 v110, v110
    v_exp_f32 v111, v111
    v_smfmac_f32_32x32x32_bf16 v[164:179], v[204:207], v[100:107], v3
    v_exp_f32 v112, v112
    v_exp_f32 v113, v113
    v_exp_f32 v114, v114
    v_exp_f32 v115, v115
    v_mfma_f32_32x32x16_bf16 v[68:83], v[212:215], v[28:31], 0
    v_exp_f32 v52, v52
    v_exp_f32 v53, v53
    v_exp_f32 v54, v54
    v_exp_f32 v55, v55
    v_mfma_f32_32x32x16_bf16 v[68:83], v[216:219], v[32:35], v[68:83]
    v_exp_f32 v56, v56
    v_exp_f32 v57, v57
    v_exp_f32 v58, v58
    v_exp_f32 v59, v59
    v_smfmac_f32_32x32x32_bf16 v[164:179], v[208:211], v[108:115], v3
    global_load_dwordx4 v[196:199], v2, s[44:45]
    global_load_dwordx4 v[200:203], v2, s[44:45] offset:1024
    global_load_dwordx4 v[204:207], v2, s[44:45] offset:2048
    global_load_dwordx4 v[208:211], v2, s[44:45] offset:3072
    v_exp_f32 v60, v60
    v_exp_f32 v61, v61
    v_exp_f32 v62, v62
    v_exp_f32 v63, v63
    v_smfmac_f32_32x32x32_bf16 v[116:131], v[220:223], v[52:59], v3
    v_exp_f32 v64, v64
    v_exp_f32 v65, v65
    v_exp_f32 v66, v66
    v_exp_f32 v67, v67
    v_mfma_f32_32x32x16_bf16 v[84:99], v[212:215], v[36:39], 0
    v_exp_f32 v68, v68
    v_exp_f32 v69, v69
    v_exp_f32 v70, v70
    v_exp_f32 v71, v71
    v_mfma_f32_32x32x16_bf16 v[84:99], v[216:219], v[40:43], v[84:99]
    v_exp_f32 v72, v72
    v_exp_f32 v73, v73
    v_exp_f32 v74, v74
    v_exp_f32 v75, v75
    v_smfmac_f32_32x32x32_bf16 v[116:131], v[224:227], v[60:67], v3
    v_exp_f32 v76, v76
    v_exp_f32 v77, v77
    v_exp_f32 v78, v78
    v_exp_f32 v79, v79
    v_smfmac_f32_32x32x32_bf16 v[132:147], v[220:223], v[68:75], v3
    v_exp_f32 v80, v80
    v_exp_f32 v81, v81
    v_exp_f32 v82, v82
    v_exp_f32 v83, v83
    v_mfma_f32_32x32x16_bf16 v[100:115], v[212:215], v[44:47], 0
    v_exp_f32 v84, v84
    v_exp_f32 v85, v85
    v_exp_f32 v86, v86
    v_exp_f32 v87, v87
    v_mfma_f32_32x32x16_bf16 v[100:115], v[216:219], v[48:51], v[100:115]
    v_exp_f32 v88, v88
    v_exp_f32 v89, v89
    v_exp_f32 v90, v90
    v_exp_f32 v91, v91
    v_smfmac_f32_32x32x32_bf16 v[132:147], v[224:227], v[76:83], v3
    v_exp_f32 v92, v92
    v_exp_f32 v93, v93
    v_exp_f32 v94, v94
    v_exp_f32 v95, v95
    v_smfmac_f32_32x32x32_bf16 v[148:163], v[220:223], v[84:91], v3
    v_exp_f32 v96, v96
    v_exp_f32 v97, v97
    v_exp_f32 v98, v98
    v_exp_f32 v99, v99
    s_waitcnt vmcnt(8)
    v_mfma_f32_32x32x16_bf16 v[52:67], v[228:231], v[20:23], 0
    v_exp_f32 v100, v100
    v_exp_f32 v101, v101
    v_exp_f32 v102, v102
    v_exp_f32 v103, v103
    v_mfma_f32_32x32x16_bf16 v[52:67], v[232:235], v[24:27], v[52:67]
    v_exp_f32 v104, v104
    v_exp_f32 v105, v105
    v_exp_f32 v106, v106
    v_exp_f32 v107, v107
    v_smfmac_f32_32x32x32_bf16 v[148:163], v[224:227], v[92:99], v3
    v_exp_f32 v108, v108
    v_exp_f32 v109, v109
    v_exp_f32 v110, v110
    v_exp_f32 v111, v111
    v_smfmac_f32_32x32x32_bf16 v[164:179], v[220:223], v[100:107], v3
    v_exp_f32 v112, v112
    v_exp_f32 v113, v113
    v_exp_f32 v114, v114
    v_exp_f32 v115, v115
    v_mfma_f32_32x32x16_bf16 v[68:83], v[228:231], v[28:31], 0
    v_exp_f32 v52, v52
    v_exp_f32 v53, v53
    v_exp_f32 v54, v54
    v_exp_f32 v55, v55
    v_mfma_f32_32x32x16_bf16 v[68:83], v[232:235], v[32:35], v[68:83]
    v_exp_f32 v56, v56
    v_exp_f32 v57, v57
    v_exp_f32 v58, v58
    v_exp_f32 v59, v59
    v_smfmac_f32_32x32x32_bf16 v[164:179], v[224:227], v[108:115], v3
    global_load_dwordx4 v[212:215], v2, s[46:47]
    global_load_dwordx4 v[216:219], v2, s[46:47] offset:1024
    global_load_dwordx4 v[220:223], v2, s[46:47] offset:2048
    global_load_dwordx4 v[224:227], v2, s[46:47] offset:3072
    v_exp_f32 v60, v60
    v_exp_f32 v61, v61
    v_exp_f32 v62, v62
    v_exp_f32 v63, v63
    v_smfmac_f32_32x32x32_bf16 v[116:131], v[236:239], v[52:59], v3
    v_exp_f32 v64, v64
    v_exp_f32 v65, v65
    v_exp_f32 v66, v66
    v_exp_f32 v67, v67
    v_mfma_f32_32x32x16_bf16 v[84:99], v[228:231], v[36:39], 0
    v_exp_f32 v68, v68
    v_exp_f32 v69, v69
    v_exp_f32 v70, v70
    v_exp_f32 v71, v71
    v_mfma_f32_32x32x16_bf16 v[84:99], v[232:235], v[40:43], v[84:99]
    v_exp_f32 v72, v72
    v_exp_f32 v73, v73
    v_exp_f32 v74, v74
    v_exp_f32 v75, v75
    v_smfmac_f32_32x32x32_bf16 v[116:131], v[240:243], v[60:67], v3
    v_exp_f32 v76, v76
    v_exp_f32 v77, v77
    v_exp_f32 v78, v78
    v_exp_f32 v79, v79
    v_smfmac_f32_32x32x32_bf16 v[132:147], v[236:239], v[68:75], v3
    v_exp_f32 v80, v80
    v_exp_f32 v81, v81
    v_exp_f32 v82, v82
    v_exp_f32 v83, v83
    v_mfma_f32_32x32x16_bf16 v[100:115], v[228:231], v[44:47], 0
    v_exp_f32 v84, v84
    v_exp_f32 v85, v85
    v_exp_f32 v86, v86
    v_exp_f32 v87, v87
    v_mfma_f32_32x32x16_bf16 v[100:115], v[232:235], v[48:51], v[100:115]
    v_exp_f32 v88, v88
    v_exp_f32 v89, v89
    v_exp_f32 v90, v90
    v_exp_f32 v91, v91
    v_smfmac_f32_32x32x32_bf16 v[132:147], v[240:243], v[76:83], v3
    v_exp_f32 v92, v92
    v_exp_f32 v93, v93
    v_exp_f32 v94, v94
    v_exp_f32 v95, v95
    v_smfmac_f32_32x32x32_bf16 v[148:163], v[236:239], v[84:91], v3
    v_exp_f32 v96, v96
    v_exp_f32 v97, v97
    v_exp_f32 v98, v98
    v_exp_f32 v99, v99
    s_waitcnt vmcnt(8)
    v_mfma_f32_32x32x16_bf16 v[52:67], v[180:183], v[20:23], 0
    v_exp_f32 v100, v100
    v_exp_f32 v101, v101
    v_exp_f32 v102, v102
    v_exp_f32 v103, v103
    v_mfma_f32_32x32x16_bf16 v[52:67], v[184:187], v[24:27], v[52:67]
    v_exp_f32 v104, v104
    v_exp_f32 v105, v105
    v_exp_f32 v106, v106
    v_exp_f32 v107, v107
    v_smfmac_f32_32x32x32_bf16 v[148:163], v[240:243], v[92:99], v3
    v_exp_f32 v108, v108
    v_exp_f32 v109, v109
    v_exp_f32 v110, v110
    v_exp_f32 v111, v111
    v_smfmac_f32_32x32x32_bf16 v[164:179], v[236:239], v[100:107], v3
    v_exp_f32 v112, v112
    v_exp_f32 v113, v113
    v_exp_f32 v114, v114
    v_exp_f32 v115, v115
    v_mfma_f32_32x32x16_bf16 v[68:83], v[180:183], v[28:31], 0
    v_exp_f32 v52, v52
    v_exp_f32 v53, v53
    v_exp_f32 v54, v54
    v_exp_f32 v55, v55
    v_mfma_f32_32x32x16_bf16 v[68:83], v[184:187], v[32:35], v[68:83]
    v_exp_f32 v56, v56
    v_exp_f32 v57, v57
    v_exp_f32 v58, v58
    v_exp_f32 v59, v59
    v_smfmac_f32_32x32x32_bf16 v[164:179], v[240:243], v[108:115], v3
    global_load_dwordx4 v[228:231], v2, s[66:67]
    global_load_dwordx4 v[232:235], v2, s[66:67] offset:1024
    global_load_dwordx4 v[236:239], v2, s[66:67] offset:2048
    global_load_dwordx4 v[240:243], v2, s[66:67] offset:3072
    v_exp_f32 v60, v60
    v_exp_f32 v61, v61
    v_exp_f32 v62, v62
    v_exp_f32 v63, v63
    v_smfmac_f32_32x32x32_bf16 v[116:131], v[188:191], v[52:59], v3
    v_exp_f32 v64, v64
    v_exp_f32 v65, v65
    v_exp_f32 v66, v66
    v_exp_f32 v67, v67
    v_mfma_f32_32x32x16_bf16 v[84:99], v[180:183], v[36:39], 0
    v_exp_f32 v68, v68
    v_exp_f32 v69, v69
    v_exp_f32 v70, v70
    v_exp_f32 v71, v71
    v_mfma_f32_32x32x16_bf16 v[84:99], v[184:187], v[40:43], v[84:99]
    v_exp_f32 v72, v72
    v_exp_f32 v73, v73
    v_exp_f32 v74, v74
    v_exp_f32 v75, v75
    v_smfmac_f32_32x32x32_bf16 v[116:131], v[192:195], v[60:67], v3
    v_exp_f32 v76, v76
    v_exp_f32 v77, v77
    v_exp_f32 v78, v78
    v_exp_f32 v79, v79
    v_smfmac_f32_32x32x32_bf16 v[132:147], v[188:191], v[68:75], v3
    v_exp_f32 v80, v80
    v_exp_f32 v81, v81
    v_exp_f32 v82, v82
    v_exp_f32 v83, v83
    v_mfma_f32_32x32x16_bf16 v[100:115], v[180:183], v[44:47], 0
    v_exp_f32 v84, v84
    v_exp_f32 v85, v85
    v_exp_f32 v86, v86
    v_exp_f32 v87, v87
    v_mfma_f32_32x32x16_bf16 v[100:115], v[184:187], v[48:51], v[100:115]
    v_exp_f32 v88, v88
    v_exp_f32 v89, v89
    v_exp_f32 v90, v90
    v_exp_f32 v91, v91
    v_smfmac_f32_32x32x32_bf16 v[132:147], v[192:195], v[76:83], v3
    v_exp_f32 v92, v92
    v_exp_f32 v93, v93
    v_exp_f32 v94, v94
    v_exp_f32 v95, v95
    v_smfmac_f32_32x32x32_bf16 v[148:163], v[188:191], v[84:91], v3
    v_exp_f32 v96, v96
    v_exp_f32 v97, v97
    v_exp_f32 v98, v98
    v_exp_f32 v99, v99
    s_waitcnt vmcnt(8)
    v_mfma_f32_32x32x16_bf16 v[52:67], v[196:199], v[20:23], 0
    v_exp_f32 v100, v100
    v_exp_f32 v101, v101
    v_exp_f32 v102, v102
    v_exp_f32 v103, v103
    v_mfma_f32_32x32x16_bf16 v[52:67], v[200:203], v[24:27], v[52:67]
    v_exp_f32 v104, v104
    v_exp_f32 v105, v105
    v_exp_f32 v106, v106
    v_exp_f32 v107, v107
    v_smfmac_f32_32x32x32_bf16 v[148:163], v[192:195], v[92:99], v3
    v_exp_f32 v108, v108
    v_exp_f32 v109, v109
    v_exp_f32 v110, v110
    v_exp_f32 v111, v111
    v_smfmac_f32_32x32x32_bf16 v[164:179], v[188:191], v[100:107], v3
    v_exp_f32 v112, v112
    v_exp_f32 v113, v113
    v_exp_f32 v114, v114
    v_exp_f32 v115, v115
    v_mfma_f32_32x32x16_bf16 v[68:83], v[196:199], v[28:31], 0
    v_exp_f32 v52, v52
    v_exp_f32 v53, v53
    v_exp_f32 v54, v54
    v_exp_f32 v55, v55
    v_mfma_f32_32x32x16_bf16 v[68:83], v[200:203], v[32:35], v[68:83]
    v_exp_f32 v56, v56
    v_exp_f32 v57, v57
    v_exp_f32 v58, v58
    v_exp_f32 v59, v59
    v_smfmac_f32_32x32x32_bf16 v[164:179], v[192:195], v[108:115], v3
    global_load_dwordx4 v[180:183], v2, s[4:5]
    global_load_dwordx4 v[184:187], v2, s[4:5] offset:1024
    global_load_dwordx4 v[188:191], v2, s[4:5] offset:2048
    global_load_dwordx4 v[192:195], v2, s[4:5] offset:3072
    v_exp_f32 v60, v60
    v_exp_f32 v61, v61
    v_exp_f32 v62, v62
    v_exp_f32 v63, v63
    v_smfmac_f32_32x32x32_bf16 v[116:131], v[204:207], v[52:59], v3
    v_exp_f32 v64, v64
    v_exp_f32 v65, v65
    v_exp_f32 v66, v66
    v_exp_f32 v67, v67
    v_mfma_f32_32x32x16_bf16 v[84:99], v[196:199], v[36:39], 0
    v_exp_f32 v68, v68
    v_exp_f32 v69, v69
    v_exp_f32 v70, v70
    v_exp_f32 v71, v71
    v_mfma_f32_32x32x16_bf16 v[84:99], v[200:203], v[40:43], v[84:99]
    v_exp_f32 v72, v72
    v_exp_f32 v73, v73
    v_exp_f32 v74, v74
    v_exp_f32 v75, v75
    v_smfmac_f32_32x32x32_bf16 v[116:131], v[208:211], v[60:67], v3
    v_exp_f32 v76, v76
    v_exp_f32 v77, v77
    v_exp_f32 v78, v78
    v_exp_f32 v79, v79
    v_smfmac_f32_32x32x32_bf16 v[132:147], v[204:207], v[68:75], v3
    v_exp_f32 v80, v80
    v_exp_f32 v81, v81
    v_exp_f32 v82, v82
    v_exp_f32 v83, v83
    v_mfma_f32_32x32x16_bf16 v[100:115], v[196:199], v[44:47], 0
    v_exp_f32 v84, v84
    v_exp_f32 v85, v85
    v_exp_f32 v86, v86
    v_exp_f32 v87, v87
    v_mfma_f32_32x32x16_bf16 v[100:115], v[200:203], v[48:51], v[100:115]
    v_exp_f32 v88, v88
    v_exp_f32 v89, v89
    v_exp_f32 v90, v90
    v_exp_f32 v91, v91
    v_smfmac_f32_32x32x32_bf16 v[132:147], v[208:211], v[76:83], v3
    v_exp_f32 v92, v92
    v_exp_f32 v93, v93
    v_exp_f32 v94, v94
    v_exp_f32 v95, v95
    v_smfmac_f32_32x32x32_bf16 v[148:163], v[204:207], v[84:91], v3
    v_exp_f32 v96, v96
    v_exp_f32 v97, v97
    v_exp_f32 v98, v98
    v_exp_f32 v99, v99
    s_waitcnt vmcnt(8)
    v_mfma_f32_32x32x16_bf16 v[52:67], v[212:215], v[20:23], 0
    v_exp_f32 v100, v100
    v_exp_f32 v101, v101
    v_exp_f32 v102, v102
    v_exp_f32 v103, v103
    v_mfma_f32_32x32x16_bf16 v[52:67], v[216:219], v[24:27], v[52:67]
    v_exp_f32 v104, v104
    v_exp_f32 v105, v105
    v_exp_f32 v106, v106
    v_exp_f32 v107, v107
    v_smfmac_f32_32x32x32_bf16 v[148:163], v[208:211], v[92:99], v3
    v_exp_f32 v108, v108
    v_exp_f32 v109, v109
    v_exp_f32 v110, v110
    v_exp_f32 v111, v111
    v_smfmac_f32_32x32x32_bf16 v[164:179], v[204:207], v[100:107], v3
    v_exp_f32 v112, v112
    v_exp_f32 v113, v113
    v_exp_f32 v114, v114
    v_exp_f32 v115, v115
    v_mfma_f32_32x32x16_bf16 v[68:83], v[212:215], v[28:31], 0
    v_exp_f32 v52, v52
    v_exp_f32 v53, v53
    v_exp_f32 v54, v54
    v_exp_f32 v55, v55
    v_mfma_f32_32x32x16_bf16 v[68:83], v[216:219], v[32:35], v[68:83]
    v_exp_f32 v56, v56
    v_exp_f32 v57, v57
    v_exp_f32 v58, v58
    v_exp_f32 v59, v59
    v_smfmac_f32_32x32x32_bf16 v[164:179], v[208:211], v[108:115], v3
    global_load_dwordx4 v[196:199], v2, s[6:7]
    global_load_dwordx4 v[200:203], v2, s[6:7] offset:1024
    global_load_dwordx4 v[204:207], v2, s[6:7] offset:2048
    global_load_dwordx4 v[208:211], v2, s[6:7] offset:3072
    v_exp_f32 v60, v60
    v_exp_f32 v61, v61
    v_exp_f32 v62, v62
    v_exp_f32 v63, v63
    v_smfmac_f32_32x32x32_bf16 v[116:131], v[220:223], v[52:59], v3
    v_exp_f32 v64, v64
    v_exp_f32 v65, v65
    v_exp_f32 v66, v66
    v_exp_f32 v67, v67
    v_mfma_f32_32x32x16_bf16 v[84:99], v[212:215], v[36:39], 0
    v_exp_f32 v68, v68
    v_exp_f32 v69, v69
    v_exp_f32 v70, v70
    v_exp_f32 v71, v71
    v_mfma_f32_32x32x16_bf16 v[84:99], v[216:219], v[40:43], v[84:99]
    v_exp_f32 v72, v72
    v_exp_f32 v73, v73
    v_exp_f32 v74, v74
    v_exp_f32 v75, v75
    v_smfmac_f32_32x32x32_bf16 v[116:131], v[224:227], v[60:67], v3
    v_exp_f32 v76, v76
    v_exp_f32 v77, v77
    v_exp_f32 v78, v78
    v_exp_f32 v79, v79
    v_smfmac_f32_32x32x32_bf16 v[132:147], v[220:223], v[68:75], v3
    v_exp_f32 v80, v80
    v_exp_f32 v81, v81
    v_exp_f32 v82, v82
    v_exp_f32 v83, v83
    v_mfma_f32_32x32x16_bf16 v[100:115], v[212:215], v[44:47], 0
    v_exp_f32 v84, v84
    v_exp_f32 v85, v85
    v_exp_f32 v86, v86
    v_exp_f32 v87, v87
    v_mfma_f32_32x32x16_bf16 v[100:115], v[216:219], v[48:51], v[100:115]
    v_exp_f32 v88, v88
    v_exp_f32 v89, v89
    v_exp_f32 v90, v90
    v_exp_f32 v91, v91
    v_smfmac_f32_32x32x32_bf16 v[132:147], v[224:227], v[76:83], v3
    v_exp_f32 v92, v92
    v_exp_f32 v93, v93
    v_exp_f32 v94, v94
    v_exp_f32 v95, v95
    v_smfmac_f32_32x32x32_bf16 v[148:163], v[220:223], v[84:91], v3
    v_exp_f32 v96, v96
    v_exp_f32 v97, v97
    v_exp_f32 v98, v98
    v_exp_f32 v99, v99
    s_waitcnt vmcnt(8)
    v_mfma_f32_32x32x16_bf16 v[52:67], v[228:231], v[20:23], 0
    v_exp_f32 v100, v100
    v_exp_f32 v101, v101
    v_exp_f32 v102, v102
    v_exp_f32 v103, v103
    v_mfma_f32_32x32x16_bf16 v[52:67], v[232:235], v[24:27], v[52:67]
    v_exp_f32 v104, v104
    v_exp_f32 v105, v105
    v_exp_f32 v106, v106
    v_exp_f32 v107, v107
    v_smfmac_f32_32x32x32_bf16 v[148:163], v[224:227], v[92:99], v3
    v_exp_f32 v108, v108
    v_exp_f32 v109, v109
    v_exp_f32 v110, v110
    v_exp_f32 v111, v111
    v_smfmac_f32_32x32x32_bf16 v[164:179], v[220:223], v[100:107], v3
    v_exp_f32 v112, v112
    v_exp_f32 v113, v113
    v_exp_f32 v114, v114
    v_exp_f32 v115, v115
    v_mfma_f32_32x32x16_bf16 v[68:83], v[228:231], v[28:31], 0
    v_exp_f32 v52, v52
    v_exp_f32 v53, v53
    v_exp_f32 v54, v54
    v_exp_f32 v55, v55
    v_mfma_f32_32x32x16_bf16 v[68:83], v[232:235], v[32:35], v[68:83]
    v_exp_f32 v56, v56
    v_exp_f32 v57, v57
    v_exp_f32 v58, v58
    v_exp_f32 v59, v59
    v_smfmac_f32_32x32x32_bf16 v[164:179], v[224:227], v[108:115], v3
    global_load_dwordx4 v[212:215], v2, s[8:9]
    global_load_dwordx4 v[216:219], v2, s[8:9] offset:1024
    global_load_dwordx4 v[220:223], v2, s[8:9] offset:2048
    global_load_dwordx4 v[224:227], v2, s[8:9] offset:3072
    v_exp_f32 v60, v60
    v_exp_f32 v61, v61
    v_exp_f32 v62, v62
    v_exp_f32 v63, v63
    v_smfmac_f32_32x32x32_bf16 v[116:131], v[236:239], v[52:59], v3
    v_exp_f32 v64, v64
    v_exp_f32 v65, v65
    v_exp_f32 v66, v66
    v_exp_f32 v67, v67
    v_mfma_f32_32x32x16_bf16 v[84:99], v[228:231], v[36:39], 0
    v_exp_f32 v68, v68
    v_exp_f32 v69, v69
    v_exp_f32 v70, v70
    v_exp_f32 v71, v71
    v_mfma_f32_32x32x16_bf16 v[84:99], v[232:235], v[40:43], v[84:99]
    v_exp_f32 v72, v72
    v_exp_f32 v73, v73
    v_exp_f32 v74, v74
    v_exp_f32 v75, v75
    v_smfmac_f32_32x32x32_bf16 v[116:131], v[240:243], v[60:67], v3
    v_exp_f32 v76, v76
    v_exp_f32 v77, v77
    v_exp_f32 v78, v78
    v_exp_f32 v79, v79
    v_smfmac_f32_32x32x32_bf16 v[132:147], v[236:239], v[68:75], v3
    v_exp_f32 v80, v80
    v_exp_f32 v81, v81
    v_exp_f32 v82, v82
    v_exp_f32 v83, v83
    v_mfma_f32_32x32x16_bf16 v[100:115], v[228:231], v[44:47], 0
    v_exp_f32 v84, v84
    v_exp_f32 v85, v85
    v_exp_f32 v86, v86
    v_exp_f32 v87, v87
    v_mfma_f32_32x32x16_bf16 v[100:115], v[232:235], v[48:51], v[100:115]
    v_exp_f32 v88, v88
    v_exp_f32 v89, v89
    v_exp_f32 v90, v90
    v_exp_f32 v91, v91
    v_smfmac_f32_32x32x32_bf16 v[132:147], v[240:243], v[76:83], v3
    v_exp_f32 v92, v92
    v_exp_f32 v93, v93
    v_exp_f32 v94, v94
    v_exp_f32 v95, v95
    v_smfmac_f32_32x32x32_bf16 v[148:163], v[236:239], v[84:91], v3
    v_exp_f32 v96, v96
    v_exp_f32 v97, v97
    v_exp_f32 v98, v98
    v_exp_f32 v99, v99
    s_waitcnt vmcnt(8)
    v_mfma_f32_32x32x16_bf16 v[52:67], v[180:183], v[20:23], 0
    v_exp_f32 v100, v100
    v_exp_f32 v101, v101
    v_exp_f32 v102, v102
    v_exp_f32 v103, v103
    v_mfma_f32_32x32x16_bf16 v[52:67], v[184:187], v[24:27], v[52:67]
    v_exp_f32 v104, v104
    v_exp_f32 v105, v105
    v_exp_f32 v106, v106
    v_exp_f32 v107, v107
    v_smfmac_f32_32x32x32_bf16 v[148:163], v[240:243], v[92:99], v3
    v_exp_f32 v108, v108
    v_exp_f32 v109, v109
    v_exp_f32 v110, v110
    v_exp_f32 v111, v111
    v_smfmac_f32_32x32x32_bf16 v[164:179], v[236:239], v[100:107], v3
    v_exp_f32 v112, v112
    v_exp_f32 v113, v113
    v_exp_f32 v114, v114
    v_exp_f32 v115, v115
    v_mfma_f32_32x32x16_bf16 v[68:83], v[180:183], v[28:31], 0
    v_exp_f32 v52, v52
    v_exp_f32 v53, v53
    v_exp_f32 v54, v54
    v_exp_f32 v55, v55
    v_mfma_f32_32x32x16_bf16 v[68:83], v[184:187], v[32:35], v[68:83]
    v_exp_f32 v56, v56
    v_exp_f32 v57, v57
    v_exp_f32 v58, v58
    v_exp_f32 v59, v59
    v_smfmac_f32_32x32x32_bf16 v[164:179], v[240:243], v[108:115], v3
    global_load_dwordx4 v[228:231], v2, s[10:11]
    global_load_dwordx4 v[232:235], v2, s[10:11] offset:1024
    global_load_dwordx4 v[236:239], v2, s[10:11] offset:2048
    global_load_dwordx4 v[240:243], v2, s[10:11] offset:3072
    v_exp_f32 v60, v60
    v_exp_f32 v61, v61
    v_exp_f32 v62, v62
    v_exp_f32 v63, v63
    v_smfmac_f32_32x32x32_bf16 v[116:131], v[188:191], v[52:59], v3
    v_exp_f32 v64, v64
    v_exp_f32 v65, v65
    v_exp_f32 v66, v66
    v_exp_f32 v67, v67
    v_mfma_f32_32x32x16_bf16 v[84:99], v[180:183], v[36:39], 0
    v_exp_f32 v68, v68
    v_exp_f32 v69, v69
    v_exp_f32 v70, v70
    v_exp_f32 v71, v71
    v_mfma_f32_32x32x16_bf16 v[84:99], v[184:187], v[40:43], v[84:99]
    v_exp_f32 v72, v72
    v_exp_f32 v73, v73
    v_exp_f32 v74, v74
    v_exp_f32 v75, v75
    v_smfmac_f32_32x32x32_bf16 v[116:131], v[192:195], v[60:67], v3
    v_exp_f32 v76, v76
    v_exp_f32 v77, v77
    v_exp_f32 v78, v78
    v_exp_f32 v79, v79
    v_smfmac_f32_32x32x32_bf16 v[132:147], v[188:191], v[68:75], v3
    v_exp_f32 v80, v80
    v_exp_f32 v81, v81
    v_exp_f32 v82, v82
    v_exp_f32 v83, v83
    v_mfma_f32_32x32x16_bf16 v[100:115], v[180:183], v[44:47], 0
    v_exp_f32 v84, v84
    v_exp_f32 v85, v85
    v_exp_f32 v86, v86
    v_exp_f32 v87, v87
    v_mfma_f32_32x32x16_bf16 v[100:115], v[184:187], v[48:51], v[100:115]
    v_exp_f32 v88, v88
    v_exp_f32 v89, v89
    v_exp_f32 v90, v90
    v_exp_f32 v91, v91
    v_smfmac_f32_32x32x32_bf16 v[132:147], v[192:195], v[76:83], v3
    v_exp_f32 v92, v92
    v_exp_f32 v93, v93
    v_exp_f32 v94, v94
    v_exp_f32 v95, v95
    v_smfmac_f32_32x32x32_bf16 v[148:163], v[188:191], v[84:91], v3
    v_exp_f32 v96, v96
    v_exp_f32 v97, v97
    v_exp_f32 v98, v98
    v_exp_f32 v99, v99
    s_waitcnt vmcnt(8)
    v_mfma_f32_32x32x16_bf16 v[52:67], v[196:199], v[20:23], 0
    v_exp_f32 v100, v100
    v_exp_f32 v101, v101
    v_exp_f32 v102, v102
    v_exp_f32 v103, v103
    v_mfma_f32_32x32x16_bf16 v[52:67], v[200:203], v[24:27], v[52:67]
    v_exp_f32 v104, v104
    v_exp_f32 v105, v105
    v_exp_f32 v106, v106
    v_exp_f32 v107, v107
    v_smfmac_f32_32x32x32_bf16 v[148:163], v[192:195], v[92:99], v3
    v_exp_f32 v108, v108
    v_exp_f32 v109, v109
    v_exp_f32 v110, v110
    v_exp_f32 v111, v111
    v_smfmac_f32_32x32x32_bf16 v[164:179], v[188:191], v[100:107], v3
    v_exp_f32 v112, v112
    v_exp_f32 v113, v113
    v_exp_f32 v114, v114
    v_exp_f32 v115, v115
    v_mfma_f32_32x32x16_bf16 v[68:83], v[196:199], v[28:31], 0
    v_exp_f32 v52, v52
    v_exp_f32 v53, v53
    v_exp_f32 v54, v54
    v_exp_f32 v55, v55
    v_mfma_f32_32x32x16_bf16 v[68:83], v[200:203], v[32:35], v[68:83]
    v_exp_f32 v56, v56
    v_exp_f32 v57, v57
    v_exp_f32 v58, v58
    v_exp_f32 v59, v59
    v_smfmac_f32_32x32x32_bf16 v[164:179], v[192:195], v[108:115], v3
    global_load_dwordx4 v[180:183], v2, s[12:13]
    global_load_dwordx4 v[184:187], v2, s[12:13] offset:1024
    global_load_dwordx4 v[188:191], v2, s[12:13] offset:2048
    global_load_dwordx4 v[192:195], v2, s[12:13] offset:3072
    v_exp_f32 v60, v60
    v_exp_f32 v61, v61
    v_exp_f32 v62, v62
    v_exp_f32 v63, v63
    v_smfmac_f32_32x32x32_bf16 v[116:131], v[204:207], v[52:59], v3
    v_exp_f32 v64, v64
    v_exp_f32 v65, v65
    v_exp_f32 v66, v66
    v_exp_f32 v67, v67
    v_mfma_f32_32x32x16_bf16 v[84:99], v[196:199], v[36:39], 0
    v_exp_f32 v68, v68
    v_exp_f32 v69, v69
    v_exp_f32 v70, v70
    v_exp_f32 v71, v71
    v_mfma_f32_32x32x16_bf16 v[84:99], v[200:203], v[40:43], v[84:99]
    v_exp_f32 v72, v72
    v_exp_f32 v73, v73
    v_exp_f32 v74, v74
    v_exp_f32 v75, v75
    v_smfmac_f32_32x32x32_bf16 v[116:131], v[208:211], v[60:67], v3
    v_exp_f32 v76, v76
    v_exp_f32 v77, v77
    v_exp_f32 v78, v78
    v_exp_f32 v79, v79
    v_smfmac_f32_32x32x32_bf16 v[132:147], v[204:207], v[68:75], v3
    v_exp_f32 v80, v80
    v_exp_f32 v81, v81
    v_exp_f32 v82, v82
    v_exp_f32 v83, v83
    v_mfma_f32_32x32x16_bf16 v[100:115], v[196:199], v[44:47], 0
    v_exp_f32 v84, v84
    v_exp_f32 v85, v85
    v_exp_f32 v86, v86
    v_exp_f32 v87, v87
    v_mfma_f32_32x32x16_bf16 v[100:115], v[200:203], v[48:51], v[100:115]
    v_exp_f32 v88, v88
    v_exp_f32 v89, v89
    v_exp_f32 v90, v90
    v_exp_f32 v91, v91
    v_smfmac_f32_32x32x32_bf16 v[132:147], v[208:211], v[76:83], v3
    v_exp_f32 v92, v92
    v_exp_f32 v93, v93
    v_exp_f32 v94, v94
    v_exp_f32 v95, v95
    v_smfmac_f32_32x32x32_bf16 v[148:163], v[204:207], v[84:91], v3
    v_exp_f32 v96, v96
    v_exp_f32 v97, v97
    v_exp_f32 v98, v98
    v_exp_f32 v99, v99
    s_waitcnt vmcnt(8)
    v_mfma_f32_32x32x16_bf16 v[52:67], v[212:215], v[20:23], 0
    v_exp_f32 v100, v100
    v_exp_f32 v101, v101
    v_exp_f32 v102, v102
    v_exp_f32 v103, v103
    v_mfma_f32_32x32x16_bf16 v[52:67], v[216:219], v[24:27], v[52:67]
    v_exp_f32 v104, v104
    v_exp_f32 v105, v105
    v_exp_f32 v106, v106
    v_exp_f32 v107, v107
    v_smfmac_f32_32x32x32_bf16 v[148:163], v[208:211], v[92:99], v3
    v_exp_f32 v108, v108
    v_exp_f32 v109, v109
    v_exp_f32 v110, v110
    v_exp_f32 v111, v111
    v_smfmac_f32_32x32x32_bf16 v[164:179], v[204:207], v[100:107], v3
    v_exp_f32 v112, v112
    v_exp_f32 v113, v113
    v_exp_f32 v114, v114
    v_exp_f32 v115, v115
    v_mfma_f32_32x32x16_bf16 v[68:83], v[212:215], v[28:31], 0
    v_exp_f32 v52, v52
    v_exp_f32 v53, v53
    v_exp_f32 v54, v54
    v_exp_f32 v55, v55
    v_mfma_f32_32x32x16_bf16 v[68:83], v[216:219], v[32:35], v[68:83]
    v_exp_f32 v56, v56
    v_exp_f32 v57, v57
    v_exp_f32 v58, v58
    v_exp_f32 v59, v59
    v_smfmac_f32_32x32x32_bf16 v[164:179], v[208:211], v[108:115], v3
    global_load_dwordx4 v[196:199], v2, s[14:15]
    global_load_dwordx4 v[200:203], v2, s[14:15] offset:1024
    global_load_dwordx4 v[204:207], v2, s[14:15] offset:2048
    global_load_dwordx4 v[208:211], v2, s[14:15] offset:3072
    v_exp_f32 v60, v60
    v_exp_f32 v61, v61
    v_exp_f32 v62, v62
    v_exp_f32 v63, v63
    v_smfmac_f32_32x32x32_bf16 v[116:131], v[220:223], v[52:59], v3
    v_exp_f32 v64, v64
    v_exp_f32 v65, v65
    v_exp_f32 v66, v66
    v_exp_f32 v67, v67
    v_mfma_f32_32x32x16_bf16 v[84:99], v[212:215], v[36:39], 0
    v_exp_f32 v68, v68
    v_exp_f32 v69, v69
    v_exp_f32 v70, v70
    v_exp_f32 v71, v71
    v_mfma_f32_32x32x16_bf16 v[84:99], v[216:219], v[40:43], v[84:99]
    v_exp_f32 v72, v72
    v_exp_f32 v73, v73
    v_exp_f32 v74, v74
    v_exp_f32 v75, v75
    v_smfmac_f32_32x32x32_bf16 v[116:131], v[224:227], v[60:67], v3
    v_exp_f32 v76, v76
    v_exp_f32 v77, v77
    v_exp_f32 v78, v78
    v_exp_f32 v79, v79
    v_smfmac_f32_32x32x32_bf16 v[132:147], v[220:223], v[68:75], v3
    v_exp_f32 v80, v80
    v_exp_f32 v81, v81
    v_exp_f32 v82, v82
    v_exp_f32 v83, v83
    v_mfma_f32_32x32x16_bf16 v[100:115], v[212:215], v[44:47], 0
    v_exp_f32 v84, v84
    v_exp_f32 v85, v85
    v_exp_f32 v86, v86
    v_exp_f32 v87, v87
    v_mfma_f32_32x32x16_bf16 v[100:115], v[216:219], v[48:51], v[100:115]
    v_exp_f32 v88, v88
    v_exp_f32 v89, v89
    v_exp_f32 v90, v90
    v_exp_f32 v91, v91
    v_smfmac_f32_32x32x32_bf16 v[132:147], v[224:227], v[76:83], v3
    v_exp_f32 v92, v92
    v_exp_f32 v93, v93
    v_exp_f32 v94, v94
    v_exp_f32 v95, v95
    v_smfmac_f32_32x32x32_bf16 v[148:163], v[220:223], v[84:91], v3
    v_exp_f32 v96, v96
    v_exp_f32 v97, v97
    v_exp_f32 v98, v98
    v_exp_f32 v99, v99
    s_waitcnt vmcnt(8)
    v_mfma_f32_32x32x16_bf16 v[52:67], v[228:231], v[20:23], 0
    v_exp_f32 v100, v100
    v_exp_f32 v101, v101
    v_exp_f32 v102, v102
    v_exp_f32 v103, v103
    v_mfma_f32_32x32x16_bf16 v[52:67], v[232:235], v[24:27], v[52:67]
    v_exp_f32 v104, v104
    v_exp_f32 v105, v105
    v_exp_f32 v106, v106
    v_exp_f32 v107, v107
    v_smfmac_f32_32x32x32_bf16 v[148:163], v[224:227], v[92:99], v3
    v_exp_f32 v108, v108
    v_exp_f32 v109, v109
    v_exp_f32 v110, v110
    v_exp_f32 v111, v111
    v_smfmac_f32_32x32x32_bf16 v[164:179], v[220:223], v[100:107], v3
    v_exp_f32 v112, v112
    v_exp_f32 v113, v113
    v_exp_f32 v114, v114
    v_exp_f32 v115, v115
    v_mfma_f32_32x32x16_bf16 v[68:83], v[228:231], v[28:31], 0
    v_exp_f32 v52, v52
    v_exp_f32 v53, v53
    v_exp_f32 v54, v54
    v_exp_f32 v55, v55
    v_mfma_f32_32x32x16_bf16 v[68:83], v[232:235], v[32:35], v[68:83]
    v_exp_f32 v56, v56
    v_exp_f32 v57, v57
    v_exp_f32 v58, v58
    v_exp_f32 v59, v59
    v_smfmac_f32_32x32x32_bf16 v[164:179], v[224:227], v[108:115], v3
    global_load_dwordx4 v[212:215], v2, s[24:25]
    global_load_dwordx4 v[216:219], v2, s[24:25] offset:1024
    global_load_dwordx4 v[220:223], v2, s[24:25] offset:2048
    global_load_dwordx4 v[224:227], v2, s[24:25] offset:3072
    v_exp_f32 v60, v60
    v_exp_f32 v61, v61
    v_exp_f32 v62, v62
    v_exp_f32 v63, v63
    v_smfmac_f32_32x32x32_bf16 v[116:131], v[236:239], v[52:59], v3
    v_exp_f32 v64, v64
    v_exp_f32 v65, v65
    v_exp_f32 v66, v66
    v_exp_f32 v67, v67
    v_mfma_f32_32x32x16_bf16 v[84:99], v[228:231], v[36:39], 0
    v_exp_f32 v68, v68
    v_exp_f32 v69, v69
    v_exp_f32 v70, v70
    v_exp_f32 v71, v71
    v_mfma_f32_32x32x16_bf16 v[84:99], v[232:235], v[40:43], v[84:99]
    v_exp_f32 v72, v72
    v_exp_f32 v73, v73
    v_exp_f32 v74, v74
    v_exp_f32 v75, v75
    v_smfmac_f32_32x32x32_bf16 v[116:131], v[240:243], v[60:67], v3
    v_exp_f32 v76, v76
    v_exp_f32 v77, v77
    v_exp_f32 v78, v78
    v_exp_f32 v79, v79
    v_smfmac_f32_32x32x32_bf16 v[132:147], v[236:239], v[68:75], v3
    v_exp_f32 v80, v80
    v_exp_f32 v81, v81
    v_exp_f32 v82, v82
    v_exp_f32 v83, v83
    v_mfma_f32_32x32x16_bf16 v[100:115], v[228:231], v[44:47], 0
    v_exp_f32 v84, v84
    v_exp_f32 v85, v85
    v_exp_f32 v86, v86
    v_exp_f32 v87, v87
    v_mfma_f32_32x32x16_bf16 v[100:115], v[232:235], v[48:51], v[100:115]
    v_exp_f32 v88, v88
    v_exp_f32 v89, v89
    v_exp_f32 v90, v90
    v_exp_f32 v91, v91
    v_smfmac_f32_32x32x32_bf16 v[132:147], v[240:243], v[76:83], v3
    v_exp_f32 v92, v92
    v_exp_f32 v93, v93
    v_exp_f32 v94, v94
    v_exp_f32 v95, v95
    v_smfmac_f32_32x32x32_bf16 v[148:163], v[236:239], v[84:91], v3
    v_exp_f32 v96, v96
    v_exp_f32 v97, v97
    v_exp_f32 v98, v98
    v_exp_f32 v99, v99
    s_waitcnt vmcnt(8)
    v_mfma_f32_32x32x16_bf16 v[52:67], v[180:183], v[20:23], 0
    v_exp_f32 v100, v100
    v_exp_f32 v101, v101
    v_exp_f32 v102, v102
    v_exp_f32 v103, v103
    v_mfma_f32_32x32x16_bf16 v[52:67], v[184:187], v[24:27], v[52:67]
    v_exp_f32 v104, v104
    v_exp_f32 v105, v105
    v_exp_f32 v106, v106
    v_exp_f32 v107, v107
    v_smfmac_f32_32x32x32_bf16 v[148:163], v[240:243], v[92:99], v3
    v_exp_f32 v108, v108
    v_exp_f32 v109, v109
    v_exp_f32 v110, v110
    v_exp_f32 v111, v111
    v_smfmac_f32_32x32x32_bf16 v[164:179], v[236:239], v[100:107], v3
    v_exp_f32 v112, v112
    v_exp_f32 v113, v113
    v_exp_f32 v114, v114
    v_exp_f32 v115, v115
    v_mfma_f32_32x32x16_bf16 v[68:83], v[180:183], v[28:31], 0
    v_exp_f32 v52, v52
    v_exp_f32 v53, v53
    v_exp_f32 v54, v54
    v_exp_f32 v55, v55
    v_mfma_f32_32x32x16_bf16 v[68:83], v[184:187], v[32:35], v[68:83]
    v_exp_f32 v56, v56
    v_exp_f32 v57, v57
    v_exp_f32 v58, v58
    v_exp_f32 v59, v59
    v_smfmac_f32_32x32x32_bf16 v[164:179], v[240:243], v[108:115], v3
    global_load_dwordx4 v[228:231], v2, s[30:31]
    global_load_dwordx4 v[232:235], v2, s[30:31] offset:1024
    global_load_dwordx4 v[236:239], v2, s[30:31] offset:2048
    global_load_dwordx4 v[240:243], v2, s[30:31] offset:3072
    v_exp_f32 v60, v60
    v_exp_f32 v61, v61
    v_exp_f32 v62, v62
    v_exp_f32 v63, v63
    v_smfmac_f32_32x32x32_bf16 v[116:131], v[188:191], v[52:59], v3
    v_exp_f32 v64, v64
    v_exp_f32 v65, v65
    v_exp_f32 v66, v66
    v_exp_f32 v67, v67
    v_mfma_f32_32x32x16_bf16 v[84:99], v[180:183], v[36:39], 0
    v_exp_f32 v68, v68
    v_exp_f32 v69, v69
    v_exp_f32 v70, v70
    v_exp_f32 v71, v71
    v_mfma_f32_32x32x16_bf16 v[84:99], v[184:187], v[40:43], v[84:99]
    v_exp_f32 v72, v72
    v_exp_f32 v73, v73
    v_exp_f32 v74, v74
    v_exp_f32 v75, v75
    v_smfmac_f32_32x32x32_bf16 v[116:131], v[192:195], v[60:67], v3
    v_exp_f32 v76, v76
    v_exp_f32 v77, v77
    v_exp_f32 v78, v78
    v_exp_f32 v79, v79
    v_smfmac_f32_32x32x32_bf16 v[132:147], v[188:191], v[68:75], v3
    v_exp_f32 v80, v80
    v_exp_f32 v81, v81
    v_exp_f32 v82, v82
    v_exp_f32 v83, v83
    v_mfma_f32_32x32x16_bf16 v[100:115], v[180:183], v[44:47], 0
    v_exp_f32 v84, v84
    v_exp_f32 v85, v85
    v_exp_f32 v86, v86
    v_exp_f32 v87, v87
    v_mfma_f32_32x32x16_bf16 v[100:115], v[184:187], v[48:51], v[100:115]
    v_exp_f32 v88, v88
    v_exp_f32 v89, v89
    v_exp_f32 v90, v90
    v_exp_f32 v91, v91
    v_smfmac_f32_32x32x32_bf16 v[132:147], v[192:195], v[76:83], v3
    v_exp_f32 v92, v92
    v_exp_f32 v93, v93
    v_exp_f32 v94, v94
    v_exp_f32 v95, v95
    v_smfmac_f32_32x32x32_bf16 v[148:163], v[188:191], v[84:91], v3
    v_exp_f32 v96, v96
    v_exp_f32 v97, v97
    v_exp_f32 v98, v98
    v_exp_f32 v99, v99
    s_waitcnt vmcnt(8)
    v_mfma_f32_32x32x16_bf16 v[52:67], v[196:199], v[20:23], 0
    v_exp_f32 v100, v100
    v_exp_f32 v101, v101
    v_exp_f32 v102, v102
    v_exp_f32 v103, v103
    v_mfma_f32_32x32x16_bf16 v[52:67], v[200:203], v[24:27], v[52:67]
    v_exp_f32 v104, v104
    v_exp_f32 v105, v105
    v_exp_f32 v106, v106
    v_exp_f32 v107, v107
    v_smfmac_f32_32x32x32_bf16 v[148:163], v[192:195], v[92:99], v3
    v_exp_f32 v108, v108
    v_exp_f32 v109, v109
    v_exp_f32 v110, v110
    v_exp_f32 v111, v111
    v_smfmac_f32_32x32x32_bf16 v[164:179], v[188:191], v[100:107], v3
    v_exp_f32 v112, v112
    v_exp_f32 v113, v113
    v_exp_f32 v114, v114
    v_exp_f32 v115, v115
    v_mfma_f32_32x32x16_bf16 v[68:83], v[196:199], v[28:31], 0
    v_exp_f32 v52, v52
    v_exp_f32 v53, v53
    v_exp_f32 v54, v54
    v_exp_f32 v55, v55
    v_mfma_f32_32x32x16_bf16 v[68:83], v[200:203], v[32:35], v[68:83]
    v_exp_f32 v56, v56
    v_exp_f32 v57, v57
    v_exp_f32 v58, v58
    v_exp_f32 v59, v59
    v_smfmac_f32_32x32x32_bf16 v[164:179], v[192:195], v[108:115], v3
    v_exp_f32 v60, v60
    v_exp_f32 v61, v61
    v_exp_f32 v62, v62
    v_exp_f32 v63, v63
    v_smfmac_f32_32x32x32_bf16 v[116:131], v[204:207], v[52:59], v3
    v_exp_f32 v64, v64
    v_exp_f32 v65, v65
    v_exp_f32 v66, v66
    v_exp_f32 v67, v67
    v_mfma_f32_32x32x16_bf16 v[84:99], v[196:199], v[36:39], 0
    v_exp_f32 v68, v68
    v_exp_f32 v69, v69
    v_exp_f32 v70, v70
    v_exp_f32 v71, v71
    v_mfma_f32_32x32x16_bf16 v[84:99], v[200:203], v[40:43], v[84:99]
    v_exp_f32 v72, v72
    v_exp_f32 v73, v73
    v_exp_f32 v74, v74
    v_exp_f32 v75, v75
    v_smfmac_f32_32x32x32_bf16 v[116:131], v[208:211], v[60:67], v3
    v_exp_f32 v76, v76
    v_exp_f32 v77, v77
    v_exp_f32 v78, v78
    v_exp_f32 v79, v79
    v_smfmac_f32_32x32x32_bf16 v[132:147], v[204:207], v[68:75], v3
    v_exp_f32 v80, v80
    v_exp_f32 v81, v81
    v_exp_f32 v82, v82
    v_exp_f32 v83, v83
    v_mfma_f32_32x32x16_bf16 v[100:115], v[196:199], v[44:47], 0
    v_exp_f32 v84, v84
    v_exp_f32 v85, v85
    v_exp_f32 v86, v86
    v_exp_f32 v87, v87
    v_mfma_f32_32x32x16_bf16 v[100:115], v[200:203], v[48:51], v[100:115]
    v_exp_f32 v88, v88
    v_exp_f32 v89, v89
    v_exp_f32 v90, v90
    v_exp_f32 v91, v91
    v_smfmac_f32_32x32x32_bf16 v[132:147], v[208:211], v[76:83], v3
    v_exp_f32 v92, v92
    v_exp_f32 v93, v93
    v_exp_f32 v94, v94
    v_exp_f32 v95, v95
    v_smfmac_f32_32x32x32_bf16 v[148:163], v[204:207], v[84:91], v3
    v_exp_f32 v96, v96
    v_exp_f32 v97, v97
    v_exp_f32 v98, v98
    v_exp_f32 v99, v99
    s_waitcnt vmcnt(4)
    v_mfma_f32_32x32x16_bf16 v[52:67], v[212:215], v[20:23], 0
    v_exp_f32 v100, v100
    v_exp_f32 v101, v101
    v_exp_f32 v102, v102
    v_exp_f32 v103, v103
    v_mfma_f32_32x32x16_bf16 v[52:67], v[216:219], v[24:27], v[52:67]
    v_exp_f32 v104, v104
    v_exp_f32 v105, v105
    v_exp_f32 v106, v106
    v_exp_f32 v107, v107
    v_smfmac_f32_32x32x32_bf16 v[148:163], v[208:211], v[92:99], v3
    v_exp_f32 v108, v108
    v_exp_f32 v109, v109
    v_exp_f32 v110, v110
    v_exp_f32 v111, v111
    v_smfmac_f32_32x32x32_bf16 v[164:179], v[204:207], v[100:107], v3
    v_exp_f32 v112, v112
    v_exp_f32 v113, v113
    v_exp_f32 v114, v114
    v_exp_f32 v115, v115
    v_mfma_f32_32x32x16_bf16 v[68:83], v[212:215], v[28:31], 0
    v_exp_f32 v52, v52
    v_exp_f32 v53, v53
    v_exp_f32 v54, v54
    v_exp_f32 v55, v55
    v_mfma_f32_32x32x16_bf16 v[68:83], v[216:219], v[32:35], v[68:83]
    v_exp_f32 v56, v56
    v_exp_f32 v57, v57
    v_exp_f32 v58, v58
    v_exp_f32 v59, v59
    v_smfmac_f32_32x32x32_bf16 v[164:179], v[208:211], v[108:115], v3
    v_exp_f32 v60, v60
    v_exp_f32 v61, v61
    v_exp_f32 v62, v62
    v_exp_f32 v63, v63
    v_smfmac_f32_32x32x32_bf16 v[116:131], v[220:223], v[52:59], v3
    v_exp_f32 v64, v64
    v_exp_f32 v65, v65
    v_exp_f32 v66, v66
    v_exp_f32 v67, v67
    v_mfma_f32_32x32x16_bf16 v[84:99], v[212:215], v[36:39], 0
    v_exp_f32 v68, v68
    v_exp_f32 v69, v69
    v_exp_f32 v70, v70
    v_exp_f32 v71, v71
    v_mfma_f32_32x32x16_bf16 v[84:99], v[216:219], v[40:43], v[84:99]
    v_exp_f32 v72, v72
    v_exp_f32 v73, v73
    v_exp_f32 v74, v74
    v_exp_f32 v75, v75
    v_smfmac_f32_32x32x32_bf16 v[116:131], v[224:227], v[60:67], v3
    v_exp_f32 v76, v76
    v_exp_f32 v77, v77
    v_exp_f32 v78, v78
    v_exp_f32 v79, v79
    v_smfmac_f32_32x32x32_bf16 v[132:147], v[220:223], v[68:75], v3
    v_exp_f32 v80, v80
    v_exp_f32 v81, v81
    v_exp_f32 v82, v82
    v_exp_f32 v83, v83
    v_mfma_f32_32x32x16_bf16 v[100:115], v[212:215], v[44:47], 0
    v_exp_f32 v84, v84
    v_exp_f32 v85, v85
    v_exp_f32 v86, v86
    v_exp_f32 v87, v87
    v_mfma_f32_32x32x16_bf16 v[100:115], v[216:219], v[48:51], v[100:115]
    v_exp_f32 v88, v88
    v_exp_f32 v89, v89
    v_exp_f32 v90, v90
    v_exp_f32 v91, v91
    v_smfmac_f32_32x32x32_bf16 v[132:147], v[224:227], v[76:83], v3
    v_exp_f32 v92, v92
    v_exp_f32 v93, v93
    v_exp_f32 v94, v94
    v_exp_f32 v95, v95
    v_smfmac_f32_32x32x32_bf16 v[148:163], v[220:223], v[84:91], v3
    v_exp_f32 v96, v96
    v_exp_f32 v97, v97
    v_exp_f32 v98, v98
    v_exp_f32 v99, v99
    s_waitcnt vmcnt(0)
    v_mfma_f32_32x32x16_bf16 v[52:67], v[228:231], v[20:23], 0
    v_exp_f32 v100, v100
    v_exp_f32 v101, v101
    v_exp_f32 v102, v102
    v_exp_f32 v103, v103
    v_mfma_f32_32x32x16_bf16 v[52:67], v[232:235], v[24:27], v[52:67]
    v_exp_f32 v104, v104
    v_exp_f32 v105, v105
    v_exp_f32 v106, v106
    v_exp_f32 v107, v107
    v_smfmac_f32_32x32x32_bf16 v[148:163], v[224:227], v[92:99], v3
    v_exp_f32 v108, v108
    v_exp_f32 v109, v109
    v_exp_f32 v110, v110
    v_exp_f32 v111, v111
    v_smfmac_f32_32x32x32_bf16 v[164:179], v[220:223], v[100:107], v3
    v_exp_f32 v112, v112
    v_exp_f32 v113, v113
    v_exp_f32 v114, v114
    v_exp_f32 v115, v115
    v_mfma_f32_32x32x16_bf16 v[68:83], v[228:231], v[28:31], 0
    v_exp_f32 v52, v52
    v_exp_f32 v53, v53
    v_exp_f32 v54, v54
    v_exp_f32 v55, v55
    v_mfma_f32_32x32x16_bf16 v[68:83], v[232:235], v[32:35], v[68:83]
    v_exp_f32 v56, v56
    v_exp_f32 v57, v57
    v_exp_f32 v58, v58
    v_exp_f32 v59, v59
    v_smfmac_f32_32x32x32_bf16 v[164:179], v[224:227], v[108:115], v3
    v_exp_f32 v60, v60
    v_exp_f32 v61, v61
    v_exp_f32 v62, v62
    v_exp_f32 v63, v63
    v_smfmac_f32_32x32x32_bf16 v[116:131], v[236:239], v[52:59], v3
    v_exp_f32 v64, v64
    v_exp_f32 v65, v65
    v_exp_f32 v66, v66
    v_exp_f32 v67, v67
    v_mfma_f32_32x32x16_bf16 v[84:99], v[228:231], v[36:39], 0
    v_exp_f32 v68, v68
    v_exp_f32 v69, v69
    v_exp_f32 v70, v70
    v_exp_f32 v71, v71
    v_mfma_f32_32x32x16_bf16 v[84:99], v[232:235], v[40:43], v[84:99]
    v_exp_f32 v72, v72
    v_exp_f32 v73, v73
    v_exp_f32 v74, v74
    v_exp_f32 v75, v75
    v_smfmac_f32_32x32x32_bf16 v[116:131], v[240:243], v[60:67], v3
    v_exp_f32 v76, v76
    v_exp_f32 v77, v77
    v_exp_f32 v78, v78
    v_exp_f32 v79, v79
    v_smfmac_f32_32x32x32_bf16 v[132:147], v[236:239], v[68:75], v3
    v_exp_f32 v80, v80
    v_exp_f32 v81, v81
    v_exp_f32 v82, v82
    v_exp_f32 v83, v83
    v_mfma_f32_32x32x16_bf16 v[100:115], v[228:231], v[44:47], 0
    v_exp_f32 v84, v84
    v_exp_f32 v85, v85
    v_exp_f32 v86, v86
    v_exp_f32 v87, v87
    v_mfma_f32_32x32x16_bf16 v[100:115], v[232:235], v[48:51], v[100:115]
    v_exp_f32 v88, v88
    v_exp_f32 v89, v89
    v_exp_f32 v90, v90
    v_exp_f32 v91, v91
    v_smfmac_f32_32x32x32_bf16 v[132:147], v[240:243], v[76:83], v3
    v_exp_f32 v92, v92
    v_exp_f32 v93, v93
    v_exp_f32 v94, v94
    v_exp_f32 v95, v95
    v_smfmac_f32_32x32x32_bf16 v[148:163], v[236:239], v[84:91], v3
    v_exp_f32 v96, v96
    v_exp_f32 v97, v97
    v_exp_f32 v98, v98
    v_exp_f32 v99, v99
    v_exp_f32 v100, v100
    v_exp_f32 v101, v101
    v_exp_f32 v102, v102
    v_exp_f32 v103, v103
    ds_write_b128 v12, v[116:119] offset:0
    ds_write_b128 v12, v[120:123] offset:1024
    ds_write_b128 v12, v[124:127] offset:2048
    ds_write_b128 v12, v[128:131] offset:3072
    v_exp_f32 v104, v104
    v_exp_f32 v105, v105
    v_exp_f32 v106, v106
    v_exp_f32 v107, v107
    v_smfmac_f32_32x32x32_bf16 v[148:163], v[240:243], v[92:99], v3
    v_exp_f32 v108, v108
    v_exp_f32 v109, v109
    v_exp_f32 v110, v110
    v_exp_f32 v111, v111
    v_smfmac_f32_32x32x32_bf16 v[164:179], v[236:239], v[100:107], v3
    ds_write_b128 v13, v[132:135] offset:0
    ds_write_b128 v13, v[136:139] offset:1024
    ds_write_b128 v13, v[140:143] offset:2048
    ds_write_b128 v13, v[144:147] offset:3072
    v_exp_f32 v112, v112
    v_exp_f32 v113, v113
    v_exp_f32 v114, v114
    v_exp_f32 v115, v115
    s_mov_b32 s34, 0x53800000
    s_nop 0
    v_smfmac_f32_32x32x32_bf16 v[164:179], v[240:243], v[108:115], v3
    ds_write_b128 v14, v[148:151] offset:0
    ds_write_b128 v14, v[152:155] offset:1024
    ds_write_b128 v14, v[156:159] offset:2048
    ds_write_b128 v14, v[160:163] offset:3072
    v_cmp_ngt_f32 vcc, s34, v128
    s_mov_b32 s35, vcc_hi
    v_cmp_ngt_f32 vcc, s34, v144
    s_or_b32 s35, s35, vcc_hi
    v_cmp_ngt_f32 vcc, s34, v160
    s_or_b32 s35, s35, vcc_hi
    s_lshl_b32 s27, s3, 2
    v_mov_b32 v4, s27
    s_mul_i32 s27, s3, 12288
    v_add_u32 v6, s27, v2
    v_mov_b32 v7, 0
    v_cmp_ngt_f32 vcc, s34, v176
    s_or_b32 s35, s35, vcc_hi
    v_mov_b32 v5, s35
    ds_write_b32 v4, v5 offset:49152
    s_waitcnt lgkmcnt(0)
    s_barrier
    ds_read_b128 v[8:11], v7 offset:49152
    ds_read_b128 v[52:55], v6 offset:0
    ds_read_b128 v[56:59], v6 offset:1024
    ds_read_b128 v[60:63], v6 offset:2048
    ds_read_b128 v[64:67], v6 offset:3072
    ds_read_b128 v[68:71], v6 offset:4096
    ds_read_b128 v[72:75], v6 offset:5120
    ds_read_b128 v[76:79], v6 offset:6144
    ds_read_b128 v[80:83], v6 offset:7168
    ds_read_b128 v[84:87], v6 offset:8192
    ds_read_b128 v[88:91], v6 offset:9216
    ds_read_b128 v[92:95], v6 offset:10240
    ds_read_b128 v[96:99], v6 offset:11264
    s_lshl_b32 s28, s22, 2
    s_add_u32 s28, s28, s3
    s_lshl_b32 s28, s28, 4
    s_add_u32 s28, s28, s21
    s_lshl_b32 s27, s28, 11
    s_add_u32 s27, s27, 0x600000
    s_lshl_b32 s28, s22, 5
    s_add_u32 s28, s28, s21
    s_lshl_b32 s28, s28, 2
    s_add_u32 s28, s28, 0x1602000
    s_waitcnt lgkmcnt(12)
    v_or_b32 v8, v8, v9
    v_or3_b32 v8, v8, v10, v11
    s_nop 0
    v_readfirstlane_b32 s35, v8
    s_nop 3
    s_cmp_lg_u32 s35, 0
    s_cselect_b32 s35, 1, 0
    s_cmp_gt_u32 s35, s33
    s_cbranch_scc1 L_retry
    s_waitcnt lgkmcnt(8)
    v_pk_add_f32 v[164:165], v[164:165], v[52:53]
    v_pk_add_f32 v[166:167], v[166:167], v[54:55]
    v_pk_add_f32 v[168:169], v[168:169], v[56:57]
    v_pk_add_f32 v[170:171], v[170:171], v[58:59]
    v_pk_add_f32 v[172:173], v[172:173], v[60:61]
    v_pk_add_f32 v[174:175], v[174:175], v[62:63]
    v_pk_add_f32 v[176:177], v[176:177], v[64:65]
    v_pk_add_f32 v[178:179], v[178:179], v[66:67]
    s_waitcnt lgkmcnt(4)
    v_pk_add_f32 v[164:165], v[164:165], v[68:69]
    v_pk_add_f32 v[166:167], v[166:167], v[70:71]
    v_pk_add_f32 v[168:169], v[168:169], v[72:73]
    v_pk_add_f32 v[170:171], v[170:171], v[74:75]
    v_pk_add_f32 v[172:173], v[172:173], v[76:77]
    v_pk_add_f32 v[174:175], v[174:175], v[78:79]
    v_pk_add_f32 v[176:177], v[176:177], v[80:81]
    v_pk_add_f32 v[178:179], v[178:179], v[82:83]
    s_waitcnt lgkmcnt(0)
    v_pk_add_f32 v[176:177], v[176:177], v[96:97]
    v_pk_add_f32 v[164:165], v[164:165], v[84:85]
    v_mov_b32 v4, v176
    v_mov_b32 v5, v176
    v_pk_add_f32 v[166:167], v[166:167], v[86:87]
    v_pk_add_f32 v[168:169], v[168:169], v[88:89]
    v_permlane32_swap_b32 v4, v5
    v_pk_add_f32 v[170:171], v[170:171], v[90:91]
    v_pk_add_f32 v[172:173], v[172:173], v[92:93]
    v_rcp_f32 v4, v5
    v_pk_add_f32 v[174:175], v[174:175], v[94:95]
    v_pk_add_f32 v[178:179], v[178:179], v[98:99]
    v_pk_mul_f32 v[164:165], v[164:165], v[4:5] op_sel_hi:[1,0]
    v_pk_mul_f32 v[166:167], v[166:167], v[4:5] op_sel_hi:[1,0]
    v_pk_mul_f32 v[168:169], v[168:169], v[4:5] op_sel_hi:[1,0]
    v_pk_mul_f32 v[170:171], v[170:171], v[4:5] op_sel_hi:[1,0]
    v_pk_mul_f32 v[172:173], v[172:173], v[4:5] op_sel_hi:[1,0]
    v_pk_mul_f32 v[174:175], v[174:175], v[4:5] op_sel_hi:[1,0]
    v_pk_mul_f32 v[176:177], v[176:177], v[4:5] op_sel_hi:[1,0]
    v_pk_mul_f32 v[178:179], v[178:179], v[4:5] op_sel_hi:[1,0]
    v_cvt_pk_bf16_f32 v164, v164, v165
    v_cvt_pk_bf16_f32 v165, v166, v167
    v_cvt_pk_bf16_f32 v166, v168, v169
    v_cvt_pk_bf16_f32 v167, v170, v171
    v_cvt_pk_bf16_f32 v168, v172, v173
    v_cvt_pk_bf16_f32 v169, v174, v175
    v_cvt_pk_bf16_f32 v170, v176, v177
    v_cvt_pk_bf16_f32 v171, v178, v179
    s_mov_b32 exec_lo, 0
    v_mov_b32 v170, 0
    v_mov_b32 v171, 0
    s_mov_b32 exec_lo, -1
    buffer_store_dwordx4 v[164:167], v2, s[16:19], s27 offen sc1
    buffer_store_dwordx4 v[168:171], v2, s[16:19], s27 offen offset:1024 sc1
    s_cmp_lt_u32 s62, 28
    s_cbranch_scc1 L_p3
    s_waitcnt vmcnt(0)
    s_barrier
    s_cmp_lg_u32 s3, 0
    s_cbranch_scc1 L_nofl0
    v_mov_b32 v11, s60
    s_mov_b64 exec, 1
    buffer_store_dword v11, off, s[16:19], s28 sc1
    s_mov_b64 exec, -1
L_nofl0:
    s_cmp_eq_u32 s59, 0
    s_cbranch_scc1 L_end
    s_sub_u32 s20, s62, 28
    s_lshl_b32 s20, s20, 2
    s_add_u32 s20, s20, s3
    s_mul_i32 s21, s61, 229376
    s_mul_i32 s22, s20, 14336
    s_add_u32 s21, s21, s22
    s_add_u32 s21, s21, 0x800000
    buffer_load_dwordx4 v[20:23], v2, s[16:19], s21 offen offset:0
    buffer_load_dwordx4 v[20:23], v2, s[16:19], s21 offen offset:1024
    buffer_load_dwordx4 v[20:23], v2, s[16:19], s21 offen offset:2048
    buffer_load_dwordx4 v[20:23], v2, s[16:19], s21 offen offset:3072
    s_add_u32 s21, s21, 4096
    buffer_load_dwordx4 v[20:23], v2, s[16:19], s21 offen offset:0
    buffer_load_dwordx4 v[20:23], v2, s[16:19], s21 offen offset:1024
    buffer_load_dwordx4 v[20:23], v2, s[16:19], s21 offen offset:2048
    buffer_load_dwordx4 v[20:23], v2, s[16:19], s21 offen offset:3072
    s_add_u32 s21, s21, 4096
    buffer_load_dwordx4 v[20:23], v2, s[16:19], s21 offen offset:0
    buffer_load_dwordx4 v[20:23], v2, s[16:19], s21 offen offset:1024
    buffer_load_dwordx4 v[20:23], v2, s[16:19], s21 offen offset:2048
    buffer_load_dwordx4 v[20:23], v2, s[16:19], s21 offen offset:3072
    s_add_u32 s21, s21, 4096
    buffer_load_dwordx4 v[20:23], v2, s[16:19], s21 offen offset:0
    buffer_load_dwordx4 v[20:23], v2, s[16:19], s21 offen offset:1024
    s_lshl_b32 s21, s61, 15
    s_lshl_b32 s22, s20, 11
    s_add_u32 s21, s21, s22
    s_add_u32 s21, s21, 0xa00000
    buffer_load_dwordx4 v[20:23], v2, s[16:19], s21 offen offset:0
    buffer_load_dwordx4 v[20:23], v2, s[16:19], s21 offen offset:1024
    s_waitcnt vmcnt(0)
    s_endpgm
L_p3:
    s_mov_b32 s31, s28
    s_and_b32 s27, s62, 3
    s_lshl_b32 s22, s61, 2
    s_add_u32 s22, s22, s27
    s_lshr_b32 s23, s62, 2
    s_lshr_b32 s26, s3, 1
    s_and_b32 s29, s3, 1
    s_lshl_b32 s30, s22, 1
    s_add_u32 s30, s30, s26
    s_lshl_b32 s72, s23, 1
    s_add_u32 s72, s72, s29
    s_mul_i32 s70, s30, 28672
    s_lshl_b32 s71, s72, 11
    s_add_u32 s70, s70, s71
    s_add_u32 s70, s70, 0x800000
    s_lshl_b32 s71, s23, 9
    s_lshl_b32 s27, s30, 12
    s_add_u32 s71, s71, s27
    s_add_u32 s71, s71, 0xa00000
    v_lshrrev_b32 v11, 5, v1
    v_bfe_u32 v12, v1, 2, 2
    v_lshl_add_u32 v12, v11, 2, v12
    v_lshlrev_b32 v7, 7, v12
    v_bfe_u32 v12, v1, 3, 1
    v_xor_b32 v12, s29, v12
    v_lshl_add_u32 v7, v12, 6, v7
    v_bfe_u32 v12, v1, 4, 1
    v_lshl_add_u32 v7, v12, 5, v7
    v_and_b32 v12, 3, v1
    v_lshl_add_u32 v7, v12, 3, v7
    v_add_u32 v7, 65536, v7
    s_lshl_b32 s33, s26, 15
    v_add_u32 v6, s33, v2
    v_and_b32 v14, 31, v1
    v_bfe_u32 v13, v1, 1, 3
    v_xor_b32 v13, v13, v11
    s_lshl_b32 s66, s29, 2
    v_xor_b32 v13, s66, v13
    v_lshlrev_b32 v15, 7, v14
    s_lshl_b32 s66, s26, 12
    s_add_u32 s66, s66, 124928
    v_add_u32 v15, s66, v15
    v_lshl_add_u32 v8, v13, 4, v15
    v_xor_b32 v13, 2, v13
    v_lshl_add_u32 v9, v13, 4, v15
    ds_read_b128 v[28:31], v8
    ds_read_b128 v[32:35], v9
    v_lshrrev_b32 v15, 1, v14
    v_lshlrev_b32 v16, 2, v11
    v_sub_u32 v15, v15, v16
    v_and_b32 v16, 1, v1
    v_lshlrev_b32 v16, 4, v16
    v_mov_b32 v17, 0x3f80
    v_lshlrev_b32 v16, v16, v17
    v_cmp_eq_u32 vcc, 0, v15
    s_nop 1
    v_cndmask_b32 v20, 0, v16, vcc
    v_cmp_eq_u32 vcc, 1, v15
    s_nop 1
    v_cndmask_b32 v21, 0, v16, vcc
    v_cmp_eq_u32 vcc, 2, v15
    s_nop 1
    v_cndmask_b32 v22, 0, v16, vcc
    v_cmp_eq_u32 vcc, 3, v15
    s_nop 1
    v_cndmask_b32 v23, 0, v16, vcc
    v_cmp_eq_u32 vcc, 8, v15
    s_nop 1
    v_cndmask_b32 v24, 0, v16, vcc
    v_cmp_eq_u32 vcc, 9, v15
    s_nop 1
    v_cndmask_b32 v25, 0, v16, vcc
    v_cmp_eq_u32 vcc, 10, v15
    s_nop 1
    v_cndmask_b32 v26, 0, v16, vcc
    v_cmp_eq_u32 vcc, 11, v15
    s_nop 1
    v_cndmask_b32 v27, 0, v16, vcc
    s_lshl_b32 s28, s30, 4
    s_add_u32 s28, s28, s72
    s_lshl_b32 s28, s28, 2
    s_add_u32 s28, s28, 0x1604000
    s_lshl_b32 s27, s29, 3
    v_lshl_add_u32 v16, v1, 4, s27
    s_waitcnt lgkmcnt(0)
    v_mfma_f32_32x32x16_bf16 v[36:51], v[20:23], v[28:31], 0
    v_mfma_f32_32x32x16_bf16 v[36:51], v[24:27], v[32:35], v[36:51]
    ds_read_b64_tr_b16 v[84:85], v7 offset:0
    ds_read_b64_tr_b16 v[86:87], v7 offset:1024
    ds_read_b64_tr_b16 v[88:89], v7 offset:2048
    ds_read_b64_tr_b16 v[90:91], v7 offset:3072
    ds_read_b64_tr_b16 v[92:93], v7 offset:3584
    ds_read_b64_tr_b16 v[94:95], v7 offset:4608
    ds_read_b64_tr_b16 v[96:97], v7 offset:5632
    ds_read_b64_tr_b16 v[98:99], v7 offset:6656
    ds_read_b64_tr_b16 v[100:101], v7 offset:7168
    ds_read_b64_tr_b16 v[102:103], v7 offset:8192
    ds_read_b64_tr_b16 v[104:105], v7 offset:9216
    ds_read_b64_tr_b16 v[106:107], v7 offset:10240
    s_waitcnt lgkmcnt(2)
    ds_read_b64_tr_b16 v[108:109], v7 offset:10752
    ds_read_b64_tr_b16 v[110:111], v7 offset:11776
    ds_read_b64_tr_b16 v[112:113], v7 offset:12800
    ds_read_b64_tr_b16 v[114:115], v7 offset:13824
    ds_read_b64_tr_b16 v[116:117], v7 offset:14336
    ds_read_b64_tr_b16 v[118:119], v7 offset:15360
    ds_read_b64_tr_b16 v[120:121], v7 offset:16384
    ds_read_b64_tr_b16 v[122:123], v7 offset:17408
    ds_read_b64_tr_b16 v[124:125], v7 offset:17920
    ds_read_b64_tr_b16 v[126:127], v7 offset:18944
    ds_read_b64_tr_b16 v[128:129], v7 offset:19968
    ds_read_b64_tr_b16 v[130:131], v7 offset:20992
    s_waitcnt lgkmcnt(2)
    ds_read_b64_tr_b16 v[132:133], v7 offset:21504
    ds_read_b64_tr_b16 v[134:135], v7 offset:22528
    ds_read_b64_tr_b16 v[136:137], v7 offset:23552
    ds_read_b64_tr_b16 v[138:139], v7 offset:24576
    ds_read_b64_tr_b16 v[140:141], v7 offset:25088
    ds_read_b64_tr_b16 v[142:143], v7 offset:26112
    ds_read_b64_tr_b16 v[144:145], v7 offset:27136
    ds_read_b64_tr_b16 v[146:147], v7 offset:28160
    s_waitcnt vmcnt(0)
    s_barrier
    s_cmp_lg_u32 s3, 0
    s_cbranch_scc1 L_nofl1
    v_mov_b32 v18, s60
    s_mov_b64 exec, 1
    buffer_store_dword v18, off, s[16:19], s31 sc1
    s_mov_b64 exec, -1
L_nofl1:
    ds_read_b64_tr_b16 v[148:149], v7 offset:28672
    ds_read_b64_tr_b16 v[150:151], v7 offset:29696
    ds_read_b64_tr_b16 v[152:153], v7 offset:30720
    ds_read_b64_tr_b16 v[154:155], v7 offset:31744
    s_waitcnt lgkmcnt(2)
    ds_read_b64_tr_b16 v[156:157], v7 offset:32256
    ds_read_b64_tr_b16 v[158:159], v7 offset:33280
    ds_read_b64_tr_b16 v[160:161], v7 offset:34304
    ds_read_b64_tr_b16 v[162:163], v7 offset:35328
    ds_read_b64_tr_b16 v[164:165], v7 offset:35840
    ds_read_b64_tr_b16 v[166:167], v7 offset:36864
    ds_read_b64_tr_b16 v[168:169], v7 offset:37888
    ds_read_b64_tr_b16 v[170:171], v7 offset:38912
    ds_read_b64_tr_b16 v[172:173], v7 offset:39424
    ds_read_b64_tr_b16 v[174:175], v7 offset:40448
    ds_read_b64_tr_b16 v[176:177], v7 offset:41472
    ds_read_b64_tr_b16 v[178:179], v7 offset:42496
    s_waitcnt lgkmcnt(2)
    ds_read_b64_tr_b16 v[180:181], v7 offset:43008
    ds_read_b64_tr_b16 v[182:183], v7 offset:44032
    ds_read_b64_tr_b16 v[184:185], v7 offset:45056
    ds_read_b64_tr_b16 v[186:187], v7 offset:46080
    ds_read_b64_tr_b16 v[188:189], v7 offset:46592
    ds_read_b64_tr_b16 v[190:191], v7 offset:47616
    ds_read_b64_tr_b16 v[192:193], v7 offset:48640
    ds_read_b64_tr_b16 v[194:195], v7 offset:49664
    ds_read_b64_tr_b16 v[196:197], v7 offset:50176
    ds_read_b64_tr_b16 v[198:199], v7 offset:51200
    ds_read_b64_tr_b16 v[200:201], v7 offset:52224
    ds_read_b64_tr_b16 v[202:203], v7 offset:53248
    s_waitcnt lgkmcnt(2)
    ds_read_b64_tr_b16 v[204:205], v7 offset:53760
    ds_read_b64_tr_b16 v[206:207], v7 offset:54784
    ds_read_b64_tr_b16 v[208:209], v7 offset:55808
    ds_read_b64_tr_b16 v[210:211], v7 offset:56832
    s_waitcnt lgkmcnt(0)
    s_barrier
    s_barrier
    s_barrier
    ds_read_b128 v[52:55], v6 offset:0
    ds_read_b128 v[56:59], v6 offset:1024
    ds_read_b128 v[60:63], v6 offset:2048
    ds_read_b128 v[64:67], v6 offset:3072
    ds_read_b128 v[68:71], v6 offset:4096
    ds_read_b128 v[72:75], v6 offset:5120
    ds_read_b128 v[76:79], v6 offset:6144
    ds_read_b128 v[80:83], v6 offset:7168
    s_waitcnt lgkmcnt(7)
    v_mfma_f32_32x32x16_bf16 v[36:51], v[84:87], v[52:55], v[36:51]
    s_waitcnt lgkmcnt(6)
    v_mfma_f32_32x32x16_bf16 v[36:51], v[88:91], v[56:59], v[36:51]
    s_waitcnt lgkmcnt(5)
    v_mfma_f32_32x32x16_bf16 v[36:51], v[92:95], v[60:63], v[36:51]
    s_waitcnt lgkmcnt(4)
    v_mfma_f32_32x32x16_bf16 v[36:51], v[96:99], v[64:67], v[36:51]
    s_waitcnt lgkmcnt(3)
    v_mfma_f32_32x32x16_bf16 v[36:51], v[100:103], v[68:71], v[36:51]
    s_waitcnt lgkmcnt(2)
    v_mfma_f32_32x32x16_bf16 v[36:51], v[104:107], v[72:75], v[36:51]
    s_waitcnt lgkmcnt(1)
    v_mfma_f32_32x32x16_bf16 v[36:51], v[108:111], v[76:79], v[36:51]
    s_waitcnt lgkmcnt(0)
    v_mfma_f32_32x32x16_bf16 v[36:51], v[112:115], v[80:83], v[36:51]
    s_barrier
    ds_read_b128 v[52:55], v6 offset:8192
    ds_read_b128 v[56:59], v6 offset:9216
    ds_read_b128 v[60:63], v6 offset:10240
    ds_read_b128 v[64:67], v6 offset:11264
    ds_read_b128 v[68:71], v6 offset:12288
    ds_read_b128 v[72:75], v6 offset:13312
    ds_read_b128 v[76:79], v6 offset:14336
    ds_read_b128 v[80:83], v6 offset:15360
    s_waitcnt lgkmcnt(7)
    v_mfma_f32_32x32x16_bf16 v[36:51], v[116:119], v[52:55], v[36:51]
    s_waitcnt lgkmcnt(6)
    v_mfma_f32_32x32x16_bf16 v[36:51], v[120:123], v[56:59], v[36:51]
    s_waitcnt lgkmcnt(5)
    v_mfma_f32_32x32x16_bf16 v[36:51], v[124:127], v[60:63], v[36:51]
    s_waitcnt lgkmcnt(4)
    v_mfma_f32_32x32x16_bf16 v[36:51], v[128:131], v[64:67], v[36:51]
    s_waitcnt lgkmcnt(3)
    v_mfma_f32_32x32x16_bf16 v[36:51], v[132:135], v[68:71], v[36:51]
    s_waitcnt lgkmcnt(2)
    v_mfma_f32_32x32x16_bf16 v[36:51], v[136:139], v[72:75], v[36:51]
    s_waitcnt lgkmcnt(1)
    v_mfma_f32_32x32x16_bf16 v[36:51], v[140:143], v[76:79], v[36:51]
    s_waitcnt lgkmcnt(0)
    v_mfma_f32_32x32x16_bf16 v[36:51], v[144:147], v[80:83], v[36:51]
    s_barrier
    ds_read_b128 v[52:55], v6 offset:16384
    ds_read_b128 v[56:59], v6 offset:17408
    ds_read_b128 v[60:63], v6 offset:18432
    ds_read_b128 v[64:67], v6 offset:19456
    ds_read_b128 v[68:71], v6 offset:20480
    ds_read_b128 v[72:75], v6 offset:21504
    ds_read_b128 v[76:79], v6 offset:22528
    ds_read_b128 v[80:83], v6 offset:23552
    s_waitcnt lgkmcnt(7)
    v_mfma_f32_32x32x16_bf16 v[36:51], v[148:151], v[52:55], v[36:51]
    s_waitcnt lgkmcnt(6)
    v_mfma_f32_32x32x16_bf16 v[36:51], v[152:155], v[56:59], v[36:51]
    s_waitcnt lgkmcnt(5)
    v_mfma_f32_32x32x16_bf16 v[36:51], v[156:159], v[60:63], v[36:51]
    s_waitcnt lgkmcnt(4)
    v_mfma_f32_32x32x16_bf16 v[36:51], v[160:163], v[64:67], v[36:51]
    s_waitcnt lgkmcnt(3)
    v_mfma_f32_32x32x16_bf16 v[36:51], v[164:167], v[68:71], v[36:51]
    s_waitcnt lgkmcnt(2)
    v_mfma_f32_32x32x16_bf16 v[36:51], v[168:171], v[72:75], v[36:51]
    s_waitcnt lgkmcnt(1)
    v_mfma_f32_32x32x16_bf16 v[36:51], v[172:175], v[76:79], v[36:51]
    s_waitcnt lgkmcnt(0)
    v_mfma_f32_32x32x16_bf16 v[36:51], v[176:179], v[80:83], v[36:51]
    s_barrier
    ds_read_b128 v[52:55], v6 offset:24576
    ds_read_b128 v[56:59], v6 offset:25600
    ds_read_b128 v[60:63], v6 offset:26624
    ds_read_b128 v[64:67], v6 offset:27648
    ds_read_b128 v[68:71], v6 offset:28672
    ds_read_b128 v[72:75], v6 offset:29696
    ds_read_b128 v[76:79], v6 offset:30720
    ds_read_b128 v[80:83], v6 offset:31744
    s_waitcnt lgkmcnt(7)
    v_mfma_f32_32x32x16_bf16 v[36:51], v[180:183], v[52:55], v[36:51]
    s_waitcnt lgkmcnt(6)
    v_mfma_f32_32x32x16_bf16 v[36:51], v[184:187], v[56:59], v[36:51]
    s_waitcnt lgkmcnt(5)
    v_mfma_f32_32x32x16_bf16 v[36:51], v[188:191], v[60:63], v[36:51]
    s_waitcnt lgkmcnt(4)
    v_mfma_f32_32x32x16_bf16 v[36:51], v[192:195], v[64:67], v[36:51]
    s_waitcnt lgkmcnt(3)
    v_mfma_f32_32x32x16_bf16 v[36:51], v[196:199], v[68:71], v[36:51]
    s_waitcnt lgkmcnt(2)
    v_mfma_f32_32x32x16_bf16 v[36:51], v[200:203], v[72:75], v[36:51]
    s_waitcnt lgkmcnt(1)
    v_mfma_f32_32x32x16_bf16 v[36:51], v[204:207], v[76:79], v[36:51]
    s_waitcnt lgkmcnt(0)
    v_mfma_f32_32x32x16_bf16 v[36:51], v[208:211], v[80:83], v[36:51]
    v_mov_b32 v12, 0
    v_mov_b32 v13, 0
    v_mov_b32 v11, 0x3f803f80
    s_nop 8
    v_cvt_pk_bf16_f32 v36, v36, v37
    v_cvt_pk_bf16_f32 v37, v38, v39
    v_cvt_pk_bf16_f32 v38, v40, v41
    v_cvt_pk_bf16_f32 v39, v42, v43
    v_cvt_pk_bf16_f32 v40, v44, v45
    v_cvt_pk_bf16_f32 v41, v46, v47
    v_cvt_pk_bf16_f32 v42, v48, v49
    v_cvt_pk_bf16_f32 v43, v50, v51
    s_cmp_eq_u32 s59, 0
    s_cbranch_scc1 L_slow1
    buffer_store_dwordx4 v[36:39], v2, s[16:19], s70 offen
    buffer_store_dwordx4 v[40:43], v2, s[16:19], s70 offen offset:1024
L_back1:
    v_dot2c_f32_bf16 v12, v36, v11
    v_dot2c_f32_bf16 v13, v36, v36
    v_dot2c_f32_bf16 v12, v37, v11
    v_dot2c_f32_bf16 v13, v37, v37
    v_dot2c_f32_bf16 v12, v38, v11
    v_dot2c_f32_bf16 v13, v38, v38
    v_dot2c_f32_bf16 v12, v39, v11
    v_dot2c_f32_bf16 v13, v39, v39
    v_dot2c_f32_bf16 v12, v40, v11
    v_dot2c_f32_bf16 v13, v40, v40
    v_dot2c_f32_bf16 v12, v41, v11
    v_dot2c_f32_bf16 v13, v41, v41
    v_dot2c_f32_bf16 v12, v42, v11
    v_dot2c_f32_bf16 v13, v42, v42
    v_dot2c_f32_bf16 v12, v43, v11
    v_dot2c_f32_bf16 v13, v43, v43
    s_nop 2
    v_mov_b32 v14, v12
    v_mov_b32 v15, v13
    s_nop 1
    v_permlane32_swap_b32 v12, v14
    v_permlane32_swap_b32 v13, v15
    s_nop 1
    v_add_f32 v12, v12, v14
    v_add_f32 v13, v13, v15
    s_mov_b32 exec_hi, 0
    s_cmp_eq_u32 s59, 0
    s_cbranch_scc1 L_slow2
    buffer_store_dwordx2 v[12:13], v16, s[16:19], s71 offen
L_back2:
    s_mov_b32 exec_hi, -1
    s_bfe_u32 s27, s62, 0x10001
    s_lshl_b32 s20, s61, 1
    s_add_u32 s20, s20, s27
    s_lshr_b32 s21, s62, 2
    s_lshl_b32 s21, s21, 1
    s_and_b32 s27, s62, 1
    s_add_u32 s21, s21, s27
    s_lshl_b32 s24, s20, 2
    s_add_u32 s24, s24, s3
    s_cmp_ge_u32 s21, 7
    s_cselect_b32 s27, 4, 0
    s_add_u32 s100, s21, s27
    s_add_u32 s101, s100, 4
    s_cmp_ge_u32 s21, 4
    s_cselect_b32 s27, 3, 0
    s_add_u32 s100, s100, s27
    s_cmp_ge_u32 s21, 11
    s_cselect_b32 s27, 3, 0
    s_add_u32 s100, s100, s27
    s_cmp_ge_u32 s21, 3
    s_cselect_b32 s27, 3, 0
    s_add_u32 s101, s101, s27
    s_cmp_ge_u32 s21, 10
    s_cselect_b32 s27, 3, 0
    s_add_u32 s101, s101, s27
    s_mul_i32 s27, s24, 114688
    s_add_u32 s27, s27, 0xc00000
    s_lshl_b32 s74, s100, 12
    s_add_u32 s74, s74, s27
    s_lshl_b32 s75, s101, 12
    s_add_u32 s75, s75, s27
    s_cmp_ge_u32 s21, 7
    s_cselect_b32 s99, 7, 0
    s_sub_u32 s99, s21, s99
    v_lshrrev_b32 v22, 5, v1
    v_and_b32 v23, 31, v1
    v_lshlrev_b32 v7, 11, v22
    v_lshl_add_u32 v7, v23, 4, v7
    v_and_b32 v6, 15, v1
    v_min_u32 v6, 13, v6
    v_lshlrev_b32 v6, 2, v6
    s_mov_b32 s64, s24
    s_lshl_b32 s64, s64, 6
    s_add_u32 s64, s64, 0x4000
    v_add_u32 v6, s64, v6
    s_lshl_b32 s64, s100, 4
    s_add_u32 s64, s64, 32704
    s_mov_b64 exec, 0xf0000
    v_lshl_add_u32 v6, v1, 2, s64
    s_lshl_b32 s64, s101, 4
    s_add_u32 s64, s64, 32688
    s_mov_b64 exec, 0xf00000
    v_lshl_add_u32 v6, v1, 2, s64
    s_mov_b64 exec, -1
    s_mov_b32 s64, 0x1600000
    s_lshl_b32 s65, s24, 12
    s_add_u32 s65, s65, 0xa00000
    s_mul_i32 s66, s24, 28672
    s_add_u32 s66, s66, 0x800000
    s_lshl_b32 s68, s99, 12
    s_add_u32 s68, s68, s66
    s_add_u32 s69, s66, 28672
    s_waitcnt vmcnt(0)
    v_mov_b32 v24, s60
    s_mov_b64 exec, 1
    s_cmp_eq_u32 s59, 0
    s_cbranch_scc1 L_slow3
    buffer_store_dword v24, off, s[16:19], s28
L_back3:
    s_mov_b64 exec, -1
    s_barrier
    s_mov_b32 s27, 0
    v_lshrrev_b32 v18, 5, v1
    v_bfe_u32 v19, v1, 2, 2
    v_lshl_add_u32 v19, v18, 2, v19
    v_lshlrev_b32 v26, 7, v19
    v_bfe_u32 v19, v1, 3, 1
    v_xor_b32 v19, s27, v19
    v_lshl_add_u32 v26, v19, 6, v26
    v_bfe_u32 v19, v1, 4, 1
    v_lshl_add_u32 v26, v19, 5, v26
    v_and_b32 v19, 3, v1
    v_lshl_add_u32 v26, v19, 3, v26
    v_xor_b32 v27, 64, v26
    v_add_u32 v28, 0x10000, v26
    v_add_u32 v29, 0x10000, v27
    v_add_u32 v30, 133120, v26
    v_add_u32 v31, 133120, v27
    s_lshl_b32 s28, s24, 4
    s_add_u32 s28, s28, s21
    s_lshl_b32 s28, s28, 2
    s_add_u32 s28, s28, 0x1606000
    s_lshl_b32 s67, s100, 10
    s_add_u32 s67, s67, 0xa80000
    s_lshl_b32 s70, s101, 10
    s_add_u32 s70, s70, 0xa80000
    s_add_u32 s71, s28, 0x4000
    v_lshlrev_b32 v8, 4, v23
    v_mov_b32 v13, 0
    v_mov_b32 v128, 0
    v_mov_b32 v129, 0
    v_mov_b32 v130, 0
    v_mov_b32 v131, 0
    s_lshl_b32 s27, s3, 7
    s_add_u32 s27, s27, 163328
    v_lshl_add_u32 v9, v23, 2, s27
    v_bfe_u32 v18, v1, 1, 4
    v_lshlrev_b32 v18, 7, v18
    v_and_b32 v3, 1, v1
    v_lshl_add_u32 v3, v3, 2, v18
    s_lshl_b32 s72, s61, 3
    s_add_u32 s72, s72, 0x1602000
    ds_read_b64_tr_b16 v[32:33], v30 offset:0
    ds_read_b64_tr_b16 v[34:35], v30 offset:1024
    ds_read_b64_tr_b16 v[36:37], v31 offset:0
    ds_read_b64_tr_b16 v[38:39], v31 offset:1024
    ds_read_b64_tr_b16 v[40:41], v28 offset:32768
    ds_read_b64_tr_b16 v[42:43], v28 offset:33792
    ds_read_b64_tr_b16 v[44:45], v30 offset:2048
    ds_read_b64_tr_b16 v[46:47], v30 offset:3072
    ds_read_b64_tr_b16 v[48:49], v31 offset:2048
    ds_read_b64_tr_b16 v[50:51], v31 offset:3072
    ds_read_b64_tr_b16 v[52:53], v28 offset:34816
    ds_read_b64_tr_b16 v[54:55], v28 offset:35840
    s_mov_b32 s34, 100000
poll_3:
    buffer_load_dword v18, v6, s[16:19], s64 offen sc1
    s_sub_u32 s34, s34, 1
    s_cbranch_scc1 polle_4
    s_waitcnt vmcnt(0)
    v_cmp_ne_u32 vcc, s60, v18
    s_cbranch_vccnz poll_3
polle_4:
    s_waitcnt vmcnt(0)
    buffer_load_dwordx4 v[132:135], v2, s[16:19], s68 offen offset:0
    buffer_load_dwordx4 v[136:139], v2, s[16:19], s68 offen offset:1024
    buffer_load_dwordx4 v[140:143], v2, s[16:19], s68 offen offset:2048
    buffer_load_dwordx4 v[144:147], v2, s[16:19], s68 offen offset:3072
    s_add_u32 s68, s68, 4096
    s_cmp_eq_u32 s68, s69
    s_cselect_b32 s68, s66, s68
    s_waitcnt vmcnt(3)
    s_waitcnt lgkmcnt(6)
    v_mfma_f32_32x32x16_bf16 v[68:83], v[32:35], v[132:135], 0
    buffer_load_dwordx4 v[148:151], v2, s[16:19], s68 offen offset:0
    ds_read_b64_tr_b16 v[56:57], v30 offset:4096
    ds_read_b64_tr_b16 v[58:59], v30 offset:5120
    v_mfma_f32_32x32x16_bf16 v[84:99], v[36:39], v[132:135], 0
    buffer_load_dwordx4 v[152:155], v2, s[16:19], s68 offen offset:1024
    ds_read_b64_tr_b16 v[60:61], v31 offset:4096
    ds_read_b64_tr_b16 v[62:63], v31 offset:5120
    v_mfma_f32_32x32x16_bf16 v[100:115], v[40:43], v[132:135], 0
    ds_read_b64_tr_b16 v[64:65], v28 offset:36864
    ds_read_b64_tr_b16 v[66:67], v28 offset:37888
    s_waitcnt vmcnt(4)
    s_waitcnt lgkmcnt(6)
    v_mfma_f32_32x32x16_bf16 v[68:83], v[44:47], v[136:139], v[68:83]
    buffer_load_dwordx4 v[156:159], v2, s[16:19], s68 offen offset:2048
    ds_read_b64_tr_b16 v[32:33], v30 offset:6144
    ds_read_b64_tr_b16 v[34:35], v30 offset:7168
    v_mfma_f32_32x32x16_bf16 v[84:99], v[48:51], v[136:139], v[84:99]
    buffer_load_dwordx4 v[160:163], v2, s[16:19], s68 offen offset:3072
    s_add_u32 s68, s68, 4096
    s_cmp_eq_u32 s68, s69
    s_cselect_b32 s68, s66, s68
    ds_read_b64_tr_b16 v[36:37], v31 offset:6144
    ds_read_b64_tr_b16 v[38:39], v31 offset:7168
    v_mfma_f32_32x32x16_bf16 v[100:115], v[52:55], v[136:139], v[100:115]
    ds_read_b64_tr_b16 v[40:41], v28 offset:38912
    ds_read_b64_tr_b16 v[42:43], v28 offset:39936
    s_waitcnt vmcnt(5)
    s_waitcnt lgkmcnt(6)
    v_mfma_f32_32x32x16_bf16 v[68:83], v[56:59], v[140:143], v[68:83]
    buffer_load_dwordx4 v[164:167], v2, s[16:19], s68 offen offset:0
    ds_read_b64_tr_b16 v[44:45], v30 offset:8192
    ds_read_b64_tr_b16 v[46:47], v30 offset:9216
    v_mfma_f32_32x32x16_bf16 v[84:99], v[60:63], v[140:143], v[84:99]
    buffer_load_dwordx4 v[168:171], v2, s[16:19], s68 offen offset:1024
    ds_read_b64_tr_b16 v[48:49], v31 offset:8192
    ds_read_b64_tr_b16 v[50:51], v31 offset:9216
    v_mfma_f32_32x32x16_bf16 v[100:115], v[64:67], v[140:143], v[100:115]
    ds_read_b64_tr_b16 v[52:53], v28 offset:40960
    ds_read_b64_tr_b16 v[54:55], v28 offset:41984
    s_waitcnt vmcnt(6)
    s_waitcnt lgkmcnt(6)
    v_mfma_f32_32x32x16_bf16 v[68:83], v[32:35], v[144:147], v[68:83]
    buffer_load_dwordx4 v[172:175], v2, s[16:19], s68 offen offset:2048
    ds_read_b64_tr_b16 v[56:57], v30 offset:10240
    ds_read_b64_tr_b16 v[58:59], v30 offset:11264
    v_mfma_f32_32x32x16_bf16 v[84:99], v[36:39], v[144:147], v[84:99]
    buffer_load_dwordx4 v[176:179], v2, s[16:19], s68 offen offset:3072
    s_add_u32 s68, s68, 4096
    s_cmp_eq_u32 s68, s69
    s_cselect_b32 s68, s66, s68
    ds_read_b64_tr_b16 v[60:61], v31 offset:10240
    ds_read_b64_tr_b16 v[62:63], v31 offset:11264
    v_mfma_f32_32x32x16_bf16 v[100:115], v[40:43], v[144:147], v[100:115]
    ds_read_b64_tr_b16 v[64:65], v28 offset:43008
    ds_read_b64_tr_b16 v[66:67], v28 offset:44032
    s_waitcnt vmcnt(7)
    s_waitcnt lgkmcnt(6)
    v_mfma_f32_32x32x16_bf16 v[68:83], v[44:47], v[148:151], v[68:83]
    buffer_load_dwordx4 v[180:183], v2, s[16:19], s68 offen offset:0
    ds_read_b64_tr_b16 v[32:33], v30 offset:12288
    ds_read_b64_tr_b16 v[34:35], v30 offset:13312
    v_mfma_f32_32x32x16_bf16 v[84:99], v[48:51], v[148:151], v[84:99]
    ds_read_b64_tr_b16 v[36:37], v31 offset:12288
    ds_read_b64_tr_b16 v[38:39], v31 offset:13312
    buffer_load_dwordx4 v[116:119], v7, s[16:19], s65 offen offset:0
    v_mfma_f32_32x32x16_bf16 v[100:115], v[52:55], v[148:151], v[100:115]
    ds_read_b64_tr_b16 v[40:41], v28 offset:45056
    ds_read_b64_tr_b16 v[42:43], v28 offset:46080
    s_waitcnt vmcnt(8)
    s_waitcnt lgkmcnt(6)
    v_mfma_f32_32x32x16_bf16 v[68:83], v[56:59], v[152:155], v[68:83]
    buffer_load_dwordx4 v[184:187], v2, s[16:19], s68 offen offset:1024
    ds_read_b64_tr_b16 v[44:45], v30 offset:14336
    ds_read_b64_tr_b16 v[46:47], v30 offset:15360
    v_mfma_f32_32x32x16_bf16 v[84:99], v[60:63], v[152:155], v[84:99]
    ds_read_b64_tr_b16 v[48:49], v31 offset:14336
    ds_read_b64_tr_b16 v[50:51], v31 offset:15360
    buffer_load_dwordx4 v[120:123], v7, s[16:19], s65 offen offset:512
    v_mfma_f32_32x32x16_bf16 v[100:115], v[64:67], v[152:155], v[100:115]
    ds_read_b64_tr_b16 v[52:53], v28 offset:47104
    ds_read_b64_tr_b16 v[54:55], v28 offset:48128
    s_waitcnt vmcnt(9)
    s_waitcnt lgkmcnt(6)
    v_mfma_f32_32x32x16_bf16 v[68:83], v[32:35], v[156:159], v[68:83]
    buffer_load_dwordx4 v[188:191], v2, s[16:19], s68 offen offset:2048
    ds_read_b64_tr_b16 v[56:57], v30 offset:16384
    ds_read_b64_tr_b16 v[58:59], v30 offset:17408
    v_mfma_f32_32x32x16_bf16 v[84:99], v[36:39], v[156:159], v[84:99]
    ds_read_b64_tr_b16 v[60:61], v31 offset:16384
    ds_read_b64_tr_b16 v[62:63], v31 offset:17408
    buffer_load_dwordx4 v[124:127], v7, s[16:19], s65 offen offset:1024
    v_mfma_f32_32x32x16_bf16 v[100:115], v[40:43], v[156:159], v[100:115]
    ds_read_b64_tr_b16 v[64:65], v28 offset:49152
    ds_read_b64_tr_b16 v[66:67], v28 offset:50176
    s_waitcnt vmcnt(10)
    s_waitcnt lgkmcnt(6)
    v_mfma_f32_32x32x16_bf16 v[68:83], v[44:47], v[160:163], v[68:83]
    buffer_load_dwordx4 v[192:195], v2, s[16:19], s68 offen offset:3072
    s_add_u32 s68, s68, 4096
    s_cmp_eq_u32 s68, s69
    s_cselect_b32 s68, s66, s68
    ds_read_b64_tr_b16 v[32:33], v30 offset:18432
    ds_read_b64_tr_b16 v[34:35], v30 offset:19456
    v_mfma_f32_32x32x16_bf16 v[84:99], v[48:51], v[160:163], v[84:99]
    ds_read_b64_tr_b16 v[36:37], v31 offset:18432
    ds_read_b64_tr_b16 v[38:39], v31 offset:19456
    s_mov_b32 exec_hi, 0
    buffer_load_dwordx4 v[128:131], v7, s[16:19], s65 offen offset:1536
    s_mov_b32 exec_hi, -1
    v_mfma_f32_32x32x16_bf16 v[100:115], v[52:55], v[160:163], v[100:115]
    ds_read_b64_tr_b16 v[40:41], v28 offset:51200
    ds_read_b64_tr_b16 v[42:43], v28 offset:52224
    s_waitcnt vmcnt(11)
    s_waitcnt lgkmcnt(6)
    v_mfma_f32_32x32x16_bf16 v[68:83], v[56:59], v[164:167], v[68:83]
    buffer_load_dwordx4 v[196:199], v2, s[16:19], s68 offen offset:0
    ds_read_b64_tr_b16 v[44:45], v30 offset:20480
    ds_read_b64_tr_b16 v[46:47], v30 offset:21504
    v_mfma_f32_32x32x16_bf16 v[84:99], v[60:63], v[164:167], v[84:99]
    ds_read_b64_tr_b16 v[48:49], v31 offset:20480
    ds_read_b64_tr_b16 v[50:51], v31 offset:21504
    v_mfma_f32_32x32x16_bf16 v[100:115], v[64:67], v[164:167], v[100:115]
    ds_read_b64_tr_b16 v[52:53], v28 offset:53248
    ds_read_b64_tr_b16 v[54:55], v28 offset:54272
    s_waitcnt vmcnt(11)
    s_waitcnt lgkmcnt(6)
    v_mfma_f32_32x32x16_bf16 v[68:83], v[32:35], v[168:171], v[68:83]
    buffer_load_dwordx4 v[200:203], v2, s[16:19], s68 offen offset:1024
    ds_read_b64_tr_b16 v[56:57], v30 offset:22528
    ds_read_b64_tr_b16 v[58:59], v30 offset:23552
    v_mfma_f32_32x32x16_bf16 v[84:99], v[36:39], v[168:171], v[84:99]
    ds_read_b64_tr_b16 v[60:61], v31 offset:22528
    ds_read_b64_tr_b16 v[62:63], v31 offset:23552
    v_mfma_f32_32x32x16_bf16 v[100:115], v[40:43], v[168:171], v[100:115]
    ds_read_b64_tr_b16 v[64:65], v28 offset:55296
    ds_read_b64_tr_b16 v[66:67], v28 offset:56320
    s_barrier
    s_waitcnt vmcnt(11)
    s_waitcnt lgkmcnt(6)
    v_mfma_f32_32x32x16_bf16 v[68:83], v[44:47], v[172:175], v[68:83]
    buffer_load_dwordx4 v[204:207], v2, s[16:19], s68 offen offset:2048
    ds_read_b64_tr_b16 v[32:33], v28 offset:0
    ds_read_b64_tr_b16 v[34:35], v28 offset:1024
    v_mfma_f32_32x32x16_bf16 v[84:99], v[48:51], v[172:175], v[84:99]
    ds_read_b64_tr_b16 v[36:37], v29 offset:0
    ds_read_b64_tr_b16 v[38:39], v29 offset:1024
    v_mfma_f32_32x32x16_bf16 v[100:115], v[52:55], v[172:175], v[100:115]
    ds_read_b64_tr_b16 v[40:41], v28 offset:57344
    ds_read_b64_tr_b16 v[42:43], v28 offset:58368
    s_waitcnt vmcnt(11)
    s_waitcnt lgkmcnt(6)
    v_mfma_f32_32x32x16_bf16 v[68:83], v[56:59], v[176:179], v[68:83]
    buffer_load_dwordx4 v[208:211], v2, s[16:19], s68 offen offset:3072
    s_add_u32 s68, s68, 4096
    s_cmp_eq_u32 s68, s69
    s_cselect_b32 s68, s66, s68
    ds_read_b64_tr_b16 v[44:45], v28 offset:2048
    ds_read_b64_tr_b16 v[46:47], v28 offset:3072
    v_mfma_f32_32x32x16_bf16 v[84:99], v[60:63], v[176:179], v[84:99]
    ds_read_b64_tr_b16 v[48:49], v29 offset:2048
    ds_read_b64_tr_b16 v[50:51], v29 offset:3072
    v_mfma_f32_32x32x16_bf16 v[100:115], v[64:67], v[176:179], v[100:115]
    ds_read_b64_tr_b16 v[52:53], v28 offset:59392
    ds_read_b64_tr_b16 v[54:55], v28 offset:60416
    s_waitcnt vmcnt(11)
    s_waitcnt lgkmcnt(6)
    v_mfma_f32_32x32x16_bf16 v[68:83], v[32:35], v[180:183], v[68:83]
    buffer_load_dwordx4 v[212:215], v2, s[16:19], s68 offen offset:0
    ds_read_b64_tr_b16 v[56:57], v28 offset:4096
    ds_read_b64_tr_b16 v[58:59], v28 offset:5120
    s_waitcnt vmcnt(5)
    v_add_f32 v116, v116, v118
    v_mfma_f32_32x32x16_bf16 v[84:99], v[36:39], v[180:183], v[84:99]
    ds_read_b64_tr_b16 v[60:61], v29 offset:4096
    ds_read_b64_tr_b16 v[62:63], v29 offset:5120
    v_add_f32 v117, v117, v119
    v_mfma_f32_32x32x16_bf16 v[100:115], v[40:43], v[180:183], v[100:115]
    ds_read_b64_tr_b16 v[64:65], v28 offset:61440
    ds_read_b64_tr_b16 v[66:67], v28 offset:62464
    v_add_f32 v116, v116, v120
    s_waitcnt lgkmcnt(6)
    v_mfma_f32_32x32x16_bf16 v[68:83], v[44:47], v[184:187], v[68:83]
    buffer_load_dwordx4 v[216:219], v2, s[16:19], s68 offen offset:1024
    ds_read_b64_tr_b16 v[32:33], v28 offset:6144
    ds_read_b64_tr_b16 v[34:35], v28 offset:7168
    v_add_f32 v117, v117, v121
    v_add_f32 v116, v116, v122
    v_mfma_f32_32x32x16_bf16 v[84:99], v[48:51], v[184:187], v[84:99]
    ds_read_b64_tr_b16 v[36:37], v29 offset:6144
    ds_read_b64_tr_b16 v[38:39], v29 offset:7168
    v_add_f32 v117, v117, v123
    v_mfma_f32_32x32x16_bf16 v[100:115], v[52:55], v[184:187], v[100:115]
    ds_read_b64_tr_b16 v[40:41], v28 offset:63488
    ds_read_b64_tr_b16 v[42:43], v28 offset:64512
    v_add_f32 v116, v116, v124
    s_waitcnt lgkmcnt(6)
    v_mfma_f32_32x32x16_bf16 v[68:83], v[56:59], v[188:191], v[68:83]
    buffer_load_dwordx4 v[220:223], v2, s[16:19], s68 offen offset:2048
    ds_read_b64_tr_b16 v[44:45], v28 offset:8192
    ds_read_b64_tr_b16 v[46:47], v28 offset:9216
    v_add_f32 v117, v117, v125
    v_add_f32 v116, v116, v126
    v_mfma_f32_32x32x16_bf16 v[84:99], v[60:63], v[188:191], v[84:99]
    ds_read_b64_tr_b16 v[48:49], v29 offset:8192
    ds_read_b64_tr_b16 v[50:51], v29 offset:9216
    v_add_f32 v117, v117, v127
    v_mfma_f32_32x32x16_bf16 v[100:115], v[64:67], v[188:191], v[100:115]
    ds_read_b64_tr_b16 v[52:53], v26 offset:0
    ds_read_b64_tr_b16 v[54:55], v26 offset:1024
    v_add_f32 v116, v116, v128
    s_waitcnt lgkmcnt(6)
    v_mfma_f32_32x32x16_bf16 v[68:83], v[32:35], v[192:195], v[68:83]
    buffer_load_dwordx4 v[224:227], v2, s[16:19], s68 offen offset:3072
    s_add_u32 s68, s68, 4096
    s_cmp_eq_u32 s68, s69
    s_cselect_b32 s68, s66, s68
    ds_read_b64_tr_b16 v[56:57], v28 offset:10240
    ds_read_b64_tr_b16 v[58:59], v28 offset:11264
    v_add_f32 v117, v117, v129
    v_mfma_f32_32x32x16_bf16 v[84:99], v[36:39], v[192:195], v[84:99]
    ds_read_b64_tr_b16 v[60:61], v29 offset:10240
    ds_read_b64_tr_b16 v[62:63], v29 offset:11264
    v_add_f32 v116, v116, v130
    v_add_f32 v117, v117, v131
    v_mfma_f32_32x32x16_bf16 v[100:115], v[40:43], v[192:195], v[100:115]
    ds_read_b64_tr_b16 v[64:65], v26 offset:2048
    ds_read_b64_tr_b16 v[66:67], v26 offset:3072
    v_mov_b32 v18, v116
    s_waitcnt vmcnt(7)
    s_waitcnt lgkmcnt(6)
    v_mfma_f32_32x32x16_bf16 v[68:83], v[44:47], v[196:199], v[68:83]
    buffer_load_dwordx4 v[228:231], v2, s[16:19], s68 offen offset:0
    ds_read_b64_tr_b16 v[32:33], v28 offset:12288
    ds_read_b64_tr_b16 v[34:35], v28 offset:13312
    v_mov_b32 v19, v117
    v_mfma_f32_32x32x16_bf16 v[84:99], v[48:51], v[196:199], v[84:99]
    ds_read_b64_tr_b16 v[36:37], v29 offset:12288
    ds_read_b64_tr_b16 v[38:39], v29 offset:13312
    s_nop 1
    v_permlane32_swap_b32 v116, v18
    v_mfma_f32_32x32x16_bf16 v[100:115], v[52:55], v[196:199], v[100:115]
    ds_read_b64_tr_b16 v[40:41], v26 offset:4096
    ds_read_b64_tr_b16 v[42:43], v26 offset:5120
    v_permlane32_swap_b32 v117, v19
    s_waitcnt vmcnt(7)
    s_waitcnt lgkmcnt(6)
    v_mfma_f32_32x32x16_bf16 v[68:83], v[56:59], v[200:203], v[68:83]
    buffer_load_dwordx4 v[232:235], v2, s[16:19], s68 offen offset:1024
    ds_read_b64_tr_b16 v[44:45], v28 offset:14336
    ds_read_b64_tr_b16 v[46:47], v28 offset:15360
    v_add_f32 v116, v116, v18
    v_mfma_f32_32x32x16_bf16 v[84:99], v[60:63], v[200:203], v[84:99]
    ds_read_b64_tr_b16 v[48:49], v29 offset:14336
    ds_read_b64_tr_b16 v[50:51], v29 offset:15360
    v_add_f32 v117, v117, v19
    v_mul_f32 v116, 0x3b124925, v116
    v_mfma_f32_32x32x16_bf16 v[100:115], v[64:67], v[200:203], v[100:115]
    ds_read_b64_tr_b16 v[52:53], v26 offset:6144
    ds_read_b64_tr_b16 v[54:55], v26 offset:7168
    v_mul_f32 v117, 0x3b124925, v117
    s_waitcnt vmcnt(7)
    s_waitcnt lgkmcnt(6)
    v_mfma_f32_32x32x16_bf16 v[68:83], v[32:35], v[204:207], v[68:83]
    buffer_load_dwordx4 v[236:239], v2, s[16:19], s68 offen offset:2048
    ds_read_b64_tr_b16 v[56:57], v28 offset:16384
    ds_read_b64_tr_b16 v[58:59], v28 offset:17408
    v_fma_f32 v117, -v116, v116, v117
    v_mfma_f32_32x32x16_bf16 v[84:99], v[36:39], v[204:207], v[84:99]
    ds_read_b64_tr_b16 v[60:61], v29 offset:16384
    ds_read_b64_tr_b16 v[62:63], v29 offset:17408
    v_sub_f32 v116, 0, v116
    v_mfma_f32_32x32x16_bf16 v[100:115], v[40:43], v[204:207], v[100:115]
    ds_read_b64_tr_b16 v[64:65], v26 offset:8192
    ds_read_b64_tr_b16 v[66:67], v26 offset:9216
    v_max_f32 v117, 0, v117
    v_and_b32 v18, 0xffff0000, v116
    s_waitcnt vmcnt(7)
    s_waitcnt lgkmcnt(6)
    v_mfma_f32_32x32x16_bf16 v[68:83], v[44:47], v[208:211], v[68:83]
    buffer_load_dwordx4 v[240:243], v2, s[16:19], s68 offen offset:3072
    ds_read_b64_tr_b16 v[32:33], v28 offset:18432
    ds_read_b64_tr_b16 v[34:35], v28 offset:19456
    v_add_f32 v117, 0x3727c5ac, v117
    v_mfma_f32_32x32x16_bf16 v[84:99], v[48:51], v[208:211], v[84:99]
    ds_read_b64_tr_b16 v[36:37], v29 offset:18432
    ds_read_b64_tr_b16 v[38:39], v29 offset:19456
    v_sub_f32 v116, v116, v18
    v_mfma_f32_32x32x16_bf16 v[100:115], v[52:55], v[208:211], v[100:115]
    ds_read_b64_tr_b16 v[40:41], v26 offset:10240
    ds_read_b64_tr_b16 v[42:43], v26 offset:11264
    v_rsq_f32 v4, v117
    v_cvt_pk_bf16_f32 v10, v18, v18
    s_waitcnt vmcnt(7)
    s_waitcnt lgkmcnt(6)
    v_mfma_f32_32x32x16_bf16 v[68:83], v[56:59], v[212:215], v[68:83]
    ds_read_b64_tr_b16 v[44:45], v28 offset:20480
    ds_read_b64_tr_b16 v[46:47], v28 offset:21504
    ds_write_b32 v9, v117
    v_mfma_f32_32x32x16_bf16 v[84:99], v[60:63], v[212:215], v[84:99]
    ds_read_b64_tr_b16 v[48:49], v29 offset:20480
    ds_read_b64_tr_b16 v[50:51], v29 offset:21504
    v_mul_f32 v117, v117, v4
    v_mfma_f32_32x32x16_bf16 v[100:115], v[64:67], v[212:215], v[100:115]
    ds_read_b64_tr_b16 v[52:53], v26 offset:12288
    ds_read_b64_tr_b16 v[54:55], v26 offset:13312
    v_and_b32 v19, 0xffff0000, v117
    v_sub_f32 v117, v117, v19
    s_waitcnt vmcnt(6)
    s_waitcnt lgkmcnt(7)
    v_mfma_f32_32x32x16_bf16 v[68:83], v[32:35], v[216:219], v[68:83]
    ds_read_b64_tr_b16 v[56:57], v28 offset:22528
    ds_read_b64_tr_b16 v[58:59], v28 offset:23552
    v_cvt_pk_bf16_f32 v12, v19, v117
    v_mfma_f32_32x32x16_bf16 v[84:99], v[36:39], v[216:219], v[84:99]
    ds_read_b64_tr_b16 v[60:61], v29 offset:22528
    ds_read_b64_tr_b16 v[62:63], v29 offset:23552
    s_mov_b32 exec_lo, 0
    v_cvt_pk_bf16_f32 v10, v116, 0
    v_mov_b32 v12, 0
    s_mov_b32 exec_lo, -1
    v_mfma_f32_32x32x16_bf16 v[100:115], v[40:43], v[216:219], v[100:115]
    ds_read_b64_tr_b16 v[64:65], v26 offset:14336
    ds_read_b64_tr_b16 v[66:67], v26 offset:15360
    v_mov_b32 v11, v10
    s_waitcnt vmcnt(5)
    s_waitcnt lgkmcnt(6)
    v_mfma_f32_32x32x16_bf16 v[68:83], v[44:47], v[220:223], v[68:83]
    ds_read_b64_tr_b16 v[32:33], v28 offset:24576
    ds_read_b64_tr_b16 v[34:35], v28 offset:25600
    v_mfma_f32_32x32x16_bf16 v[84:99], v[48:51], v[220:223], v[84:99]
    ds_read_b64_tr_b16 v[36:37], v29 offset:24576
    ds_read_b64_tr_b16 v[38:39], v29 offset:25600
    v_mfma_f32_32x32x16_bf16 v[100:115], v[52:55], v[220:223], v[100:115]
    ds_read_b64_tr_b16 v[40:41], v26 offset:16384
    ds_read_b64_tr_b16 v[42:43], v26 offset:17408
    s_waitcnt vmcnt(4)
    s_waitcnt lgkmcnt(6)
    v_mfma_f32_32x32x16_bf16 v[68:83], v[56:59], v[224:227], v[68:83]
    ds_read_b64_tr_b16 v[44:45], v28 offset:26624
    ds_read_b64_tr_b16 v[46:47], v28 offset:27648
    buffer_load_dwordx4 v[120:123], v8, s[16:19], s67 offen offset:0
    v_mfma_f32_32x32x16_bf16 v[84:99], v[60:63], v[224:227], v[84:99]
    ds_read_b64_tr_b16 v[48:49], v29 offset:26624
    ds_read_b64_tr_b16 v[50:51], v29 offset:27648
    v_mfma_f32_32x32x16_bf16 v[100:115], v[64:67], v[224:227], v[100:115]
    ds_read_b64_tr_b16 v[52:53], v26 offset:18432
    ds_read_b64_tr_b16 v[54:55], v26 offset:19456
    s_waitcnt vmcnt(4)
    s_waitcnt lgkmcnt(6)
    v_mfma_f32_32x32x16_bf16 v[68:83], v[32:35], v[228:231], v[68:83]
    ds_read_b64_tr_b16 v[56:57], v28 offset:28672
    ds_read_b64_tr_b16 v[58:59], v28 offset:29696
    buffer_load_dwordx4 v[124:127], v8, s[16:19], s67 offen offset:512
    v_mfma_f32_32x32x16_bf16 v[84:99], v[36:39], v[228:231], v[84:99]
    ds_read_b64_tr_b16 v[60:61], v29 offset:28672
    ds_read_b64_tr_b16 v[62:63], v29 offset:29696
    v_mfma_f32_32x32x16_bf16 v[100:115], v[40:43], v[228:231], v[100:115]
    ds_read_b64_tr_b16 v[64:65], v26 offset:20480
    ds_read_b64_tr_b16 v[66:67], v26 offset:21504
    s_waitcnt vmcnt(4)
    s_waitcnt lgkmcnt(6)
    v_mfma_f32_32x32x16_bf16 v[68:83], v[44:47], v[232:235], v[68:83]
    ds_read_b64_tr_b16 v[32:33], v28 offset:30720
    ds_read_b64_tr_b16 v[34:35], v28 offset:31744
    buffer_load_dwordx4 v[128:131], v8, s[16:19], s70 offen offset:0
    v_mfma_f32_32x32x16_bf16 v[84:99], v[48:51], v[232:235], v[84:99]
    ds_read_b64_tr_b16 v[36:37], v29 offset:30720
    ds_read_b64_tr_b16 v[38:39], v29 offset:31744
    v_mfma_f32_32x32x16_bf16 v[100:115], v[52:55], v[232:235], v[100:115]
    ds_read_b64_tr_b16 v[40:41], v26 offset:22528
    ds_read_b64_tr_b16 v[42:43], v26 offset:23552
    s_waitcnt vmcnt(4)
    s_waitcnt lgkmcnt(6)
    v_mfma_f32_32x32x16_bf16 v[68:83], v[56:59], v[236:239], v[68:83]
    ds_read_b64_tr_b16 v[44:45], v29 offset:32768
    ds_read_b64_tr_b16 v[46:47], v29 offset:33792
    v_mfma_f32_32x32x16_bf16 v[84:99], v[60:63], v[236:239], v[84:99]
    ds_read_b64_tr_b16 v[48:49], v29 offset:34816
    ds_read_b64_tr_b16 v[50:51], v29 offset:35840
    v_mfma_f32_32x32x16_bf16 v[100:115], v[64:67], v[236:239], v[100:115]
    ds_read_b64_tr_b16 v[52:53], v29 offset:36864
    ds_read_b64_tr_b16 v[54:55], v29 offset:37888
    s_waitcnt vmcnt(3)
    s_waitcnt lgkmcnt(6)
    s_barrier
    v_mfma_f32_32x32x16_bf16 v[68:83], v[32:35], v[240:243], v[68:83]
    v_mfma_f32_32x32x16_bf16 v[84:99], v[36:39], v[240:243], v[84:99]
    v_mfma_f32_32x32x16_bf16 v[100:115], v[40:43], v[240:243], v[100:115]
    s_waitcnt vmcnt(0)
    v_mfma_f32_32x32x16_bf16 v[68:83], v[120:123], v[10:13], v[68:83]
    v_mfma_f32_32x32x16_bf16 v[84:99], v[124:127], v[10:13], v[84:99]
    v_mfma_f32_32x32x16_bf16 v[100:115], v[128:131], v[10:13], v[100:115]
    s_waitcnt lgkmcnt(4)
    v_mfma_f32_32x32x16_bf16 v[116:131], v[44:47], v[132:135], 0
    ds_read_b64_tr_b16 v[56:57], v29 offset:38912
    ds_read_b64_tr_b16 v[58:59], v29 offset:39936
    s_waitcnt lgkmcnt(4)
    v_mfma_f32_32x32x16_bf16 v[116:131], v[48:51], v[136:139], v[116:131]
    ds_read_b64_tr_b16 v[60:61], v29 offset:40960
    ds_read_b64_tr_b16 v[62:63], v29 offset:41984
    s_waitcnt lgkmcnt(4)
    v_mfma_f32_32x32x16_bf16 v[116:131], v[52:55], v[140:143], v[116:131]
    ds_read_b64_tr_b16 v[64:65], v29 offset:43008
    ds_read_b64_tr_b16 v[66:67], v29 offset:44032
    v_max_f32 v68, 0, v68
    v_max_f32 v69, 0, v69
    v_max_f32 v70, 0, v70
    v_max_f32 v71, 0, v71
    v_max_f32 v72, 0, v72
    v_max_f32 v73, 0, v73
    v_max_f32 v74, 0, v74
    v_max_f32 v75, 0, v75
    v_max_f32 v76, 0, v76
    v_max_f32 v77, 0, v77
    v_max_f32 v78, 0, v78
    s_waitcnt lgkmcnt(4)
    v_mfma_f32_32x32x16_bf16 v[116:131], v[56:59], v[144:147], v[116:131]
    ds_read_b64_tr_b16 v[32:33], v29 offset:45056
    ds_read_b64_tr_b16 v[34:35], v29 offset:46080
    v_max_f32 v79, 0, v79
    v_max_f32 v80, 0, v80
    v_max_f32 v81, 0, v81
    v_max_f32 v82, 0, v82
    v_max_f32 v83, 0, v83
    v_mul_f32 v68, v68, v68
    v_mul_f32 v69, v69, v69
    v_mul_f32 v70, v70, v70
    v_mul_f32 v71, v71, v71
    v_mul_f32 v72, v72, v72
    buffer_load_dwordx4 v[132:135], v8, s[16:19], s70 offen offset:512
    s_waitcnt lgkmcnt(4)
    v_mfma_f32_32x32x16_bf16 v[116:131], v[60:63], v[148:151], v[116:131]
    ds_read_b64_tr_b16 v[36:37], v29 offset:47104
    ds_read_b64_tr_b16 v[38:39], v29 offset:48128
    v_mul_f32 v73, v73, v73
    v_mul_f32 v74, v74, v74
    v_mul_f32 v75, v75, v75
    v_mul_f32 v76, v76, v76
    v_mul_f32 v77, v77, v77
    v_mul_f32 v78, v78, v78
    v_mul_f32 v79, v79, v79
    v_mul_f32 v80, v80, v80
    v_mul_f32 v81, v81, v81
    v_mul_f32 v82, v82, v82
    v_mul_f32 v83, v83, v83
    s_waitcnt lgkmcnt(4)
    v_mfma_f32_32x32x16_bf16 v[116:131], v[64:67], v[152:155], v[116:131]
    ds_read_b64_tr_b16 v[40:41], v29 offset:49152
    ds_read_b64_tr_b16 v[42:43], v29 offset:50176
    v_cvt_pk_bf16_f32 v68, v68, v69
    v_cvt_pk_bf16_f32 v69, v70, v71
    v_cvt_pk_bf16_f32 v70, v72, v73
    v_cvt_pk_bf16_f32 v71, v74, v75
    v_cvt_pk_bf16_f32 v72, v76, v77
    v_cvt_pk_bf16_f32 v73, v78, v79
    v_cvt_pk_bf16_f32 v74, v80, v81
    v_cvt_pk_bf16_f32 v75, v82, v83
    buffer_store_dwordx4 v[68:71], v2, s[16:19], s74 offen offset:0 sc1
    buffer_store_dwordx4 v[72:75], v2, s[16:19], s74 offen offset:1024 sc1
    s_waitcnt lgkmcnt(4)
    v_mfma_f32_32x32x16_bf16 v[116:131], v[32:35], v[156:159], v[116:131]
    ds_read_b64_tr_b16 v[44:45], v29 offset:51200
    ds_read_b64_tr_b16 v[46:47], v29 offset:52224
    v_max_f32 v84, 0, v84
    v_max_f32 v85, 0, v85
    v_max_f32 v86, 0, v86
    v_max_f32 v87, 0, v87
    v_max_f32 v88, 0, v88
    v_max_f32 v89, 0, v89
    v_max_f32 v90, 0, v90
    v_max_f32 v91, 0, v91
    v_max_f32 v92, 0, v92
    v_max_f32 v93, 0, v93
    v_max_f32 v94, 0, v94
    s_waitcnt lgkmcnt(4)
    v_mfma_f32_32x32x16_bf16 v[116:131], v[36:39], v[160:163], v[116:131]
    ds_read_b64_tr_b16 v[48:49], v29 offset:53248
    ds_read_b64_tr_b16 v[50:51], v29 offset:54272
    v_max_f32 v95, 0, v95
    v_max_f32 v96, 0, v96
    v_max_f32 v97, 0, v97
    v_max_f32 v98, 0, v98
    v_max_f32 v99, 0, v99
    v_mul_f32 v84, v84, v84
    v_mul_f32 v85, v85, v85
    v_mul_f32 v86, v86, v86
    v_mul_f32 v87, v87, v87
    v_mul_f32 v88, v88, v88
    s_waitcnt lgkmcnt(4)
    v_mfma_f32_32x32x16_bf16 v[116:131], v[40:43], v[164:167], v[116:131]
    ds_read_b64_tr_b16 v[52:53], v29 offset:55296
    ds_read_b64_tr_b16 v[54:55], v29 offset:56320
    v_mul_f32 v89, v89, v89
    v_mul_f32 v90, v90, v90
    v_mul_f32 v91, v91, v91
    v_mul_f32 v92, v92, v92
    v_mul_f32 v93, v93, v93
    v_mul_f32 v94, v94, v94
    v_mul_f32 v95, v95, v95
    v_mul_f32 v96, v96, v96
    v_mul_f32 v97, v97, v97
    v_mul_f32 v98, v98, v98
    v_mul_f32 v99, v99, v99
    s_waitcnt lgkmcnt(4)
    v_mfma_f32_32x32x16_bf16 v[116:131], v[44:47], v[168:171], v[116:131]
    ds_read_b64_tr_b16 v[56:57], v29 offset:57344
    ds_read_b64_tr_b16 v[58:59], v29 offset:58368
    v_cvt_pk_bf16_f32 v84, v84, v85
    v_cvt_pk_bf16_f32 v85, v86, v87
    v_cvt_pk_bf16_f32 v86, v88, v89
    v_cvt_pk_bf16_f32 v87, v90, v91
    v_cvt_pk_bf16_f32 v88, v92, v93
    v_cvt_pk_bf16_f32 v89, v94, v95
    v_cvt_pk_bf16_f32 v90, v96, v97
    v_cvt_pk_bf16_f32 v91, v98, v99
    buffer_store_dwordx4 v[84:87], v2, s[16:19], s74 offen offset:2048 sc1
    buffer_store_dwordx4 v[88:91], v2, s[16:19], s74 offen offset:3072 sc1
    s_waitcnt lgkmcnt(4)
    v_mfma_f32_32x32x16_bf16 v[116:131], v[48:51], v[172:175], v[116:131]
    ds_read_b64_tr_b16 v[60:61], v29 offset:59392
    ds_read_b64_tr_b16 v[62:63], v29 offset:60416
    v_max_f32 v100, 0, v100
    v_max_f32 v101, 0, v101
    v_max_f32 v102, 0, v102
    v_max_f32 v103, 0, v103
    v_max_f32 v104, 0, v104
    v_max_f32 v105, 0, v105
    v_max_f32 v106, 0, v106
    v_max_f32 v107, 0, v107
    v_max_f32 v108, 0, v108
    s_waitcnt lgkmcnt(4)
    v_mfma_f32_32x32x16_bf16 v[116:131], v[52:55], v[176:179], v[116:131]
    ds_read_b64_tr_b16 v[64:65], v29 offset:61440
    ds_read_b64_tr_b16 v[66:67], v29 offset:62464
    v_max_f32 v109, 0, v109
    v_max_f32 v110, 0, v110
    v_max_f32 v111, 0, v111
    v_max_f32 v112, 0, v112
    v_max_f32 v113, 0, v113
    v_max_f32 v114, 0, v114
    v_max_f32 v115, 0, v115
    v_mul_f32 v100, v100, v100
    s_waitcnt lgkmcnt(4)
    v_mfma_f32_32x32x16_bf16 v[116:131], v[56:59], v[180:183], v[116:131]
    ds_read_b64_tr_b16 v[32:33], v29 offset:63488
    ds_read_b64_tr_b16 v[34:35], v29 offset:64512
    v_mul_f32 v101, v101, v101
    v_mul_f32 v102, v102, v102
    v_mul_f32 v103, v103, v103
    v_mul_f32 v104, v104, v104
    v_mul_f32 v105, v105, v105
    v_mul_f32 v106, v106, v106
    v_mul_f32 v107, v107, v107
    v_mul_f32 v108, v108, v108
    v_mul_f32 v109, v109, v109
    s_waitcnt lgkmcnt(4)
    v_mfma_f32_32x32x16_bf16 v[116:131], v[60:63], v[184:187], v[116:131]
    ds_read_b64_tr_b16 v[36:37], v27 offset:0
    ds_read_b64_tr_b16 v[38:39], v27 offset:1024
    v_mul_f32 v110, v110, v110
    v_mul_f32 v111, v111, v111
    v_mul_f32 v112, v112, v112
    v_mul_f32 v113, v113, v113
    v_mul_f32 v114, v114, v114
    v_mul_f32 v115, v115, v115
    v_cvt_pk_bf16_f32 v100, v100, v101
    v_cvt_pk_bf16_f32 v101, v102, v103
    s_waitcnt lgkmcnt(4)
    v_mfma_f32_32x32x16_bf16 v[116:131], v[64:67], v[188:191], v[116:131]
    ds_read_b64_tr_b16 v[40:41], v27 offset:2048
    ds_read_b64_tr_b16 v[42:43], v27 offset:3072
    v_cvt_pk_bf16_f32 v102, v104, v105
    v_cvt_pk_bf16_f32 v103, v106, v107
    v_cvt_pk_bf16_f32 v104, v108, v109
    v_cvt_pk_bf16_f32 v105, v110, v111
    v_cvt_pk_bf16_f32 v106, v112, v113
    v_cvt_pk_bf16_f32 v107, v114, v115
    buffer_store_dwordx4 v[100:103], v2, s[16:19], s75 offen offset:0 sc1
    buffer_store_dwordx4 v[104:107], v2, s[16:19], s75 offen offset:1024 sc1
    s_waitcnt lgkmcnt(4)
    v_mfma_f32_32x32x16_bf16 v[116:131], v[32:35], v[192:195], v[116:131]
    ds_read_b64_tr_b16 v[44:45], v27 offset:4096
    ds_read_b64_tr_b16 v[46:47], v27 offset:5120
    s_waitcnt lgkmcnt(4)
    v_mfma_f32_32x32x16_bf16 v[116:131], v[36:39], v[196:199], v[116:131]
    ds_read_b64_tr_b16 v[48:49], v27 offset:6144
    ds_read_b64_tr_b16 v[50:51], v27 offset:7168
    s_waitcnt lgkmcnt(4)
    v_mfma_f32_32x32x16_bf16 v[116:131], v[40:43], v[200:203], v[116:131]
    ds_read_b64_tr_b16 v[52:53], v27 offset:8192
    ds_read_b64_tr_b16 v[54:55], v27 offset:9216
    s_waitcnt lgkmcnt(4)
    v_mfma_f32_32x32x16_bf16 v[116:131], v[44:47], v[204:207], v[116:131]
    ds_read_b64_tr_b16 v[56:57], v27 offset:10240
    ds_read_b64_tr_b16 v[58:59], v27 offset:11264
    s_waitcnt lgkmcnt(4)
    v_mfma_f32_32x32x16_bf16 v[116:131], v[48:51], v[208:211], v[116:131]
    ds_read_b64_tr_b16 v[60:61], v27 offset:12288
    ds_read_b64_tr_b16 v[62:63], v27 offset:13312
    s_waitcnt lgkmcnt(4)
    v_mfma_f32_32x32x16_bf16 v[116:131], v[52:55], v[212:215], v[116:131]
    ds_read_b64_tr_b16 v[64:65], v27 offset:14336
    ds_read_b64_tr_b16 v[66:67], v27 offset:15360
    s_waitcnt lgkmcnt(4)
    v_mfma_f32_32x32x16_bf16 v[116:131], v[56:59], v[216:219], v[116:131]
    ds_read_b64_tr_b16 v[32:33], v27 offset:16384
    ds_read_b64_tr_b16 v[34:35], v27 offset:17408
    s_waitcnt lgkmcnt(4)
    v_mfma_f32_32x32x16_bf16 v[116:131], v[60:63], v[220:223], v[116:131]
    ds_read_b64_tr_b16 v[36:37], v27 offset:18432
    ds_read_b64_tr_b16 v[38:39], v27 offset:19456
    s_waitcnt lgkmcnt(4)
    v_mfma_f32_32x32x16_bf16 v[116:131], v[64:67], v[224:227], v[116:131]
    ds_read_b64_tr_b16 v[40:41], v27 offset:20480
    ds_read_b64_tr_b16 v[42:43], v27 offset:21504
    s_waitcnt lgkmcnt(4)
    v_mfma_f32_32x32x16_bf16 v[116:131], v[32:35], v[228:231], v[116:131]
    ds_read_b64_tr_b16 v[44:45], v27 offset:22528
    ds_read_b64_tr_b16 v[46:47], v27 offset:23552
    s_waitcnt lgkmcnt(4)
    v_mfma_f32_32x32x16_bf16 v[116:131], v[36:39], v[232:235], v[116:131]
    s_waitcnt lgkmcnt(2)
    v_mfma_f32_32x32x16_bf16 v[116:131], v[40:43], v[236:239], v[116:131]
    s_waitcnt lgkmcnt(0)
    v_mfma_f32_32x32x16_bf16 v[116:131], v[44:47], v[240:243], v[116:131]
    s_waitcnt vmcnt(6)
    v_mfma_f32_32x32x16_bf16 v[116:131], v[132:135], v[10:13], v[116:131]
    s_nop 7
    s_nop 3
    v_max_f32 v116, 0, v116
    v_max_f32 v117, 0, v117
    v_max_f32 v118, 0, v118
    v_max_f32 v119, 0, v119
    v_max_f32 v120, 0, v120
    v_max_f32 v121, 0, v121
    v_max_f32 v122, 0, v122
    v_max_f32 v123, 0, v123
    v_max_f32 v124, 0, v124
    v_max_f32 v125, 0, v125
    v_max_f32 v126, 0, v126
    v_max_f32 v127, 0, v127
    v_max_f32 v128, 0, v128
    v_max_f32 v129, 0, v129
    v_max_f32 v130, 0, v130
    v_max_f32 v131, 0, v131
    v_mul_f32 v116, v116, v116
    v_mul_f32 v117, v117, v117
    v_mul_f32 v118, v118, v118
    v_mul_f32 v119, v119, v119
    v_mul_f32 v120, v120, v120
    v_mul_f32 v121, v121, v121
    v_mul_f32 v122, v122, v122
    v_mul_f32 v123, v123, v123
    v_mul_f32 v124, v124, v124
    v_mul_f32 v125, v125, v125
    v_mul_f32 v126, v126, v126
    v_mul_f32 v127, v127, v127
    v_mul_f32 v128, v128, v128
    v_mul_f32 v129, v129, v129
    v_mul_f32 v130, v130, v130
    v_mul_f32 v131, v131, v131
    v_cvt_pk_bf16_f32 v116, v116, v117
    v_cvt_pk_bf16_f32 v117, v118, v119
    v_cvt_pk_bf16_f32 v118, v120, v121
    v_cvt_pk_bf16_f32 v119, v122, v123
    v_cvt_pk_bf16_f32 v120, v124, v125
    v_cvt_pk_bf16_f32 v121, v126, v127
    v_cvt_pk_bf16_f32 v122, v128, v129
    v_cvt_pk_bf16_f32 v123, v130, v131
    buffer_store_dwordx4 v[116:119], v2, s[16:19], s75 offen offset:2048 sc1
    buffer_store_dwordx4 v[120:123], v2, s[16:19], s75 offen offset:3072 sc1
    s_waitcnt vmcnt(0)
    v_mov_b32 v18, s60
    s_mov_b64 exec, 1
    s_cmp_eq_u32 s59, 0
    s_cbranch_scc1 L_slow4
    buffer_store_dword v18, off, s[16:19], s28
L_back4:
    s_mov_b64 exec, -1
L_end:
    s_endpgm
L_B2:
    s_cmp_ge_u32 s62, 28
    s_cbranch_scc1 L_Bidle
    s_and_b32 s27, s62, 3
    s_lshl_b32 s22, s61, 2
    s_add_u32 s22, s22, s27
    s_lshr_b32 s23, s62, 2
    s_lshr_b32 s26, s3, 1
    s_and_b32 s29, s3, 1
    s_lshl_b32 s30, s22, 1
    s_add_u32 s30, s30, s26
    s_lshl_b32 s72, s23, 1
    s_add_u32 s72, s72, s29
    s_mul_i32 s70, s30, 28672
    s_lshl_b32 s71, s72, 11
    s_add_u32 s70, s70, s71
    s_add_u32 s70, s70, 0x800000
    s_lshl_b32 s71, s23, 9
    s_lshl_b32 s27, s30, 12
    s_add_u32 s71, s71, s27
    s_add_u32 s71, s71, 0xa00000
    v_lshrrev_b32 v8, 3, v1
    v_and_b32 v9, 7, v1
    v_mul_u32_u24 v11, 896, v8
    v_bfe_u32 v10, v1, 4, 1
    v_lshlrev_b32 v10, 2, v10
    v_xor_b32 v10, v9, v10
    v_lshl_add_u32 v64, v10, 4, v11
    v_add_u32 v65, 6144, v64
    v_add_u32 v66, 12288, v64
    v_add_u32 v67, 18432, v64
    s_mov_b32 s8, s48
    s_mov_b32 s9, s49
    s_mov_b32 s10, 0x188000
    s_mov_b32 s11, 0x00020000
    v_lshrrev_b32 v12, 5, v1
    v_bfe_u32 v13, v1, 2, 2
    v_lshl_add_u32 v13, v12, 2, v13
    v_lshlrev_b32 v4, 7, v13
    v_bfe_u32 v13, v1, 3, 1
    v_xor_b32 v13, s29, v13
    v_lshl_add_u32 v4, v13, 6, v4
    v_bfe_u32 v13, v1, 4, 1
    v_lshl_add_u32 v4, v13, 5, v4
    v_and_b32 v13, 3, v1
    v_lshl_add_u32 v4, v13, 3, v4
    v_xor_b32 v5, 64, v4
    s_mul_i32 s31, s3, 401408
    s_lshl_b32 s32, s23, 7
    s_add_u32 s31, s31, s32
    s_mul_i32 s33, s3, 14336
    s_add_u32 s33, s33, 65536
    v_add_u32 v6, s33, v4
    v_add_u32 v7, s33, v5
    v_lshrrev_b32 v8, 3, v1
    v_and_b32 v9, 7, v1
    v_mul_u32_u24 v11, 896, v8
    v_lshrrev_b32 v10, 1, v8
    v_xor_b32 v10, v9, v10
    v_lshl_add_u32 v18, v10, 4, v11
    v_xor_b32 v10, 4, v10
    v_lshl_add_u32 v19, v10, 4, v11
    v_add_u32 v19, 7168, v19
    v_lshrrev_b32 v8, 3, v1
    v_and_b32 v9, 7, v1
    v_mul_u32_u24 v11, 3584, v8
    v_bfe_u32 v10, v1, 4, 1
    v_lshlrev_b32 v10, 2, v10
    v_xor_b32 v10, v9, v10
    v_lshl_add_u32 v24, v10, 4, v11
    v_add_u32 v25, 27648, v24
    v_and_b32 v26, 15, v1
    v_lshlrev_b32 v26, 2, v26
    v_mov_b32 v11, 0
    s_mov_b32 s12, s40
    s_mov_b32 s13, s41
    s_mov_b32 s14, 0x62000
    s_mov_b32 s15, 0x00020000
    s_mov_b32 s64, s44
    s_mov_b32 s65, s45
    s_mov_b32 s66, 0x188000
    s_mov_b32 s67, 0x00020000
    s_mov_b32 s76, s36
    s_mov_b32 s77, s37
    s_mov_b32 s78, 0x1c0000
    s_mov_b32 s79, 0x00020000
    s_bfe_u32 s27, s62, 0x10001
    s_lshl_b32 s20, s61, 1
    s_add_u32 s20, s20, s27
    s_lshr_b32 s21, s62, 2
    s_lshl_b32 s21, s21, 1
    s_and_b32 s27, s62, 1
    s_add_u32 s21, s21, s27
    s_lshl_b32 s24, s20, 2
    s_add_u32 s24, s24, s3
    s_cmp_ge_u32 s21, 7
    s_cselect_b32 s27, 4, 0
    s_add_u32 s100, s21, s27
    s_add_u32 s101, s100, 4
    s_cmp_ge_u32 s21, 4
    s_cselect_b32 s27, 3, 0
    s_add_u32 s100, s100, s27
    s_cmp_ge_u32 s21, 11
    s_cselect_b32 s27, 3, 0
    s_add_u32 s100, s100, s27
    s_cmp_ge_u32 s21, 3
    s_cselect_b32 s27, 3, 0
    s_add_u32 s101, s101, s27
    s_cmp_ge_u32 s21, 10
    s_cselect_b32 s27, 3, 0
    s_add_u32 s101, s101, s27
    s_mul_i32 s27, s24, 114688
    s_add_u32 s27, s27, 0xc00000
    s_lshl_b32 s74, s100, 12
    s_add_u32 s74, s74, s27
    s_lshl_b32 s75, s101, 12
    s_add_u32 s75, s75, s27
    s_cmp_ge_u32 s21, 7
    s_cselect_b32 s99, 7, 0
    s_sub_u32 s99, s21, s99
    s_lshl_b32 s27, s22, 6
    s_lshl_b32 s35, s3, 4
    s_add_u32 s27, s27, s35
    s_mul_i32 s27, s27, 896
    s_add_u32 s27, s27, s32
    s_lshl_b32 s35, s3, 11
    s_add_u32 m0, s35, 124928
    s_nop 0
    buffer_load_dwordx4 v18, s[76:79], s27 offen lds
    s_add_u32 m0, m0, 1024
    s_nop 0
    buffer_load_dwordx4 v19, s[76:79], s27 offen lds
    s_barrier
    s_and_b32 s98, s62, 3
    s_lshl_b32 s98, s98, 1
    s_mov_b32 s97, s98
    s_lshl_b32 s27, s97, 11
    s_add_u32 m0, s27, s33
    s_mul_i32 s27, s97, 14336
    s_add_u32 s27, s27, s31
    s_waitcnt vmcnt(4)
    buffer_load_dwordx4 v64, s[8:11], s27 offen lds
    s_waitcnt vmcnt(4)
    buffer_load_dwordx4 v65, s[8:11], s27 offen offset:1024 lds
    s_add_u32 s97, s97, 1
    s_cmp_eq_u32 s97, 7
    s_cselect_b32 s97, 0, s97
    s_lshl_b32 s27, s97, 11
    s_add_u32 m0, s27, s33
    s_mul_i32 s27, s97, 14336
    s_add_u32 s27, s27, s31
    s_waitcnt vmcnt(4)
    buffer_load_dwordx4 v64, s[8:11], s27 offen lds
    s_waitcnt vmcnt(4)
    buffer_load_dwordx4 v65, s[8:11], s27 offen offset:1024 lds
    s_add_u32 s97, s97, 1
    s_cmp_eq_u32 s97, 7
    s_cselect_b32 s97, 0, s97
    s_lshl_b32 s27, s97, 11
    s_add_u32 m0, s27, s33
    s_mul_i32 s27, s97, 14336
    s_add_u32 s27, s27, s31
    s_waitcnt vmcnt(4)
    buffer_load_dwordx4 v64, s[8:11], s27 offen lds
    s_waitcnt vmcnt(4)
    buffer_load_dwordx4 v65, s[8:11], s27 offen offset:1024 lds
    s_add_u32 s97, s97, 1
    s_cmp_eq_u32 s97, 7
    s_cselect_b32 s97, 0, s97
    s_lshl_b32 s27, s97, 11
    s_add_u32 m0, s27, s33
    s_mul_i32 s27, s97, 14336
    s_add_u32 s27, s27, s31
    s_waitcnt vmcnt(4)
    buffer_load_dwordx4 v64, s[8:11], s27 offen lds
    s_waitcnt vmcnt(4)
    buffer_load_dwordx4 v65, s[8:11], s27 offen offset:1024 lds
    s_add_u32 s97, s97, 1
    s_cmp_eq_u32 s97, 7
    s_cselect_b32 s97, 0, s97
    s_lshl_b32 s27, s97, 11
    s_add_u32 m0, s27, s33
    s_mul_i32 s27, s97, 14336
    s_add_u32 s27, s27, s31
    s_waitcnt vmcnt(4)
    buffer_load_dwordx4 v64, s[8:11], s27 offen lds
    s_waitcnt vmcnt(4)
    buffer_load_dwordx4 v65, s[8:11], s27 offen offset:1024 lds
    s_add_u32 s97, s97, 1
    s_cmp_eq_u32 s97, 7
    s_cselect_b32 s97, 0, s97
    s_lshl_b32 s27, s97, 11
    s_add_u32 m0, s27, s33
    s_mul_i32 s27, s97, 14336
    s_add_u32 s27, s27, s31
    s_waitcnt vmcnt(4)
    buffer_load_dwordx4 v64, s[8:11], s27 offen lds
    s_waitcnt vmcnt(4)
    buffer_load_dwordx4 v65, s[8:11], s27 offen offset:1024 lds
    s_add_u32 s97, s97, 1
    s_cmp_eq_u32 s97, 7
    s_cselect_b32 s97, 0, s97
    s_lshl_b32 s27, s97, 11
    s_add_u32 m0, s27, s33
    s_mul_i32 s27, s97, 14336
    s_add_u32 s27, s27, s31
    s_waitcnt vmcnt(4)
    buffer_load_dwordx4 v64, s[8:11], s27 offen lds
    s_waitcnt vmcnt(4)
    buffer_load_dwordx4 v65, s[8:11], s27 offen offset:1024 lds
    s_waitcnt vmcnt(0)
    ds_read_b64_tr_b16 v[132:133], v6 offset:0
    ds_read_b64_tr_b16 v[134:135], v6 offset:1024
    ds_read_b64_tr_b16 v[136:137], v7 offset:0
    ds_read_b64_tr_b16 v[138:139], v7 offset:1024
    ds_read_b64_tr_b16 v[140:141], v6 offset:2048
    ds_read_b64_tr_b16 v[142:143], v6 offset:3072
    ds_read_b64_tr_b16 v[144:145], v7 offset:2048
    ds_read_b64_tr_b16 v[146:147], v7 offset:3072
    ds_read_b64_tr_b16 v[148:149], v6 offset:4096
    ds_read_b64_tr_b16 v[150:151], v6 offset:5120
    ds_read_b64_tr_b16 v[152:153], v7 offset:4096
    ds_read_b64_tr_b16 v[154:155], v7 offset:5120
    s_waitcnt lgkmcnt(0)
    ds_read_b64_tr_b16 v[156:157], v6 offset:6144
    ds_read_b64_tr_b16 v[158:159], v6 offset:7168
    ds_read_b64_tr_b16 v[160:161], v7 offset:6144
    ds_read_b64_tr_b16 v[162:163], v7 offset:7168
    ds_read_b64_tr_b16 v[164:165], v6 offset:8192
    ds_read_b64_tr_b16 v[166:167], v6 offset:9216
    ds_read_b64_tr_b16 v[168:169], v7 offset:8192
    ds_read_b64_tr_b16 v[170:171], v7 offset:9216
    ds_read_b64_tr_b16 v[172:173], v6 offset:10240
    ds_read_b64_tr_b16 v[174:175], v6 offset:11264
    ds_read_b64_tr_b16 v[176:177], v7 offset:10240
    ds_read_b64_tr_b16 v[178:179], v7 offset:11264
    s_waitcnt lgkmcnt(0)
    ds_read_b64_tr_b16 v[180:181], v6 offset:12288
    ds_read_b64_tr_b16 v[182:183], v6 offset:13312
    ds_read_b64_tr_b16 v[184:185], v7 offset:12288
    ds_read_b64_tr_b16 v[186:187], v7 offset:13312
    s_waitcnt lgkmcnt(0)
    s_mov_b32 s97, s98
    s_lshl_b32 s27, s97, 11
    s_add_u32 m0, s27, s33
    s_mul_i32 s27, s97, 14336
    s_add_u32 s27, s27, s31
    s_add_u32 s27, s27, 100352
    buffer_load_dwordx4 v64, s[8:11], s27 offen lds
    buffer_load_dwordx4 v65, s[8:11], s27 offen offset:1024 lds
    s_add_u32 s97, s97, 1
    s_cmp_eq_u32 s97, 7
    s_cselect_b32 s97, 0, s97
    s_lshl_b32 s27, s97, 11
    s_add_u32 m0, s27, s33
    s_mul_i32 s27, s97, 14336
    s_add_u32 s27, s27, s31
    s_add_u32 s27, s27, 100352
    buffer_load_dwordx4 v64, s[8:11], s27 offen lds
    buffer_load_dwordx4 v65, s[8:11], s27 offen offset:1024 lds
    s_add_u32 s97, s97, 1
    s_cmp_eq_u32 s97, 7
    s_cselect_b32 s97, 0, s97
    s_lshl_b32 s27, s97, 11
    s_add_u32 m0, s27, s33
    s_mul_i32 s27, s97, 14336
    s_add_u32 s27, s27, s31
    s_add_u32 s27, s27, 100352
    buffer_load_dwordx4 v64, s[8:11], s27 offen lds
    s_waitcnt vmcnt(4)
    buffer_load_dwordx4 v65, s[8:11], s27 offen offset:1024 lds
    s_add_u32 s97, s97, 1
    s_cmp_eq_u32 s97, 7
    s_cselect_b32 s97, 0, s97
    s_lshl_b32 s27, s97, 11
    s_add_u32 m0, s27, s33
    s_mul_i32 s27, s97, 14336
    s_add_u32 s27, s27, s31
    s_add_u32 s27, s27, 100352
    s_waitcnt vmcnt(4)
    buffer_load_dwordx4 v64, s[8:11], s27 offen lds
    s_waitcnt vmcnt(4)
    buffer_load_dwordx4 v65, s[8:11], s27 offen offset:1024 lds
    s_add_u32 s97, s97, 1
    s_cmp_eq_u32 s97, 7
    s_cselect_b32 s97, 0, s97
    s_lshl_b32 s27, s97, 11
    s_add_u32 m0, s27, s33
    s_mul_i32 s27, s97, 14336
    s_add_u32 s27, s27, s31
    s_add_u32 s27, s27, 100352
    s_waitcnt vmcnt(4)
    buffer_load_dwordx4 v64, s[8:11], s27 offen lds
    s_waitcnt vmcnt(4)
    buffer_load_dwordx4 v65, s[8:11], s27 offen offset:1024 lds
    s_add_u32 s97, s97, 1
    s_cmp_eq_u32 s97, 7
    s_cselect_b32 s97, 0, s97
    s_lshl_b32 s27, s97, 11
    s_add_u32 m0, s27, s33
    s_mul_i32 s27, s97, 14336
    s_add_u32 s27, s27, s31
    s_add_u32 s27, s27, 100352
    s_waitcnt vmcnt(4)
    buffer_load_dwordx4 v64, s[8:11], s27 offen lds
    s_waitcnt vmcnt(4)
    buffer_load_dwordx4 v65, s[8:11], s27 offen offset:1024 lds
    s_add_u32 s97, s97, 1
    s_cmp_eq_u32 s97, 7
    s_cselect_b32 s97, 0, s97
    s_lshl_b32 s27, s97, 11
    s_add_u32 m0, s27, s33
    s_mul_i32 s27, s97, 14336
    s_add_u32 s27, s27, s31
    s_add_u32 s27, s27, 100352
    s_waitcnt vmcnt(4)
    buffer_load_dwordx4 v64, s[8:11], s27 offen lds
    s_waitcnt vmcnt(4)
    buffer_load_dwordx4 v65, s[8:11], s27 offen offset:1024 lds
    s_waitcnt vmcnt(0)
    ds_read_b64_tr_b16 v[188:189], v6 offset:0
    ds_read_b64_tr_b16 v[190:191], v6 offset:1024
    ds_read_b64_tr_b16 v[192:193], v7 offset:0
    ds_read_b64_tr_b16 v[194:195], v7 offset:1024
    ds_read_b64_tr_b16 v[196:197], v6 offset:2048
    ds_read_b64_tr_b16 v[198:199], v6 offset:3072
    ds_read_b64_tr_b16 v[200:201], v7 offset:2048
    ds_read_b64_tr_b16 v[202:203], v7 offset:3072
    ds_read_b64_tr_b16 v[204:205], v6 offset:4096
    ds_read_b64_tr_b16 v[206:207], v6 offset:5120
    ds_read_b64_tr_b16 v[208:209], v7 offset:4096
    ds_read_b64_tr_b16 v[210:211], v7 offset:5120
    s_waitcnt lgkmcnt(0)
    ds_read_b64_tr_b16 v[212:213], v6 offset:6144
    ds_read_b64_tr_b16 v[214:215], v6 offset:7168
    ds_read_b64_tr_b16 v[216:217], v7 offset:6144
    ds_read_b64_tr_b16 v[218:219], v7 offset:7168
    ds_read_b64_tr_b16 v[220:221], v6 offset:8192
    ds_read_b64_tr_b16 v[222:223], v6 offset:9216
    ds_read_b64_tr_b16 v[224:225], v7 offset:8192
    ds_read_b64_tr_b16 v[226:227], v7 offset:9216
    ds_read_b64_tr_b16 v[228:229], v6 offset:10240
    ds_read_b64_tr_b16 v[230:231], v6 offset:11264
    ds_read_b64_tr_b16 v[232:233], v7 offset:10240
    ds_read_b64_tr_b16 v[234:235], v7 offset:11264
    s_waitcnt lgkmcnt(0)
    ds_read_b64_tr_b16 v[236:237], v6 offset:12288
    ds_read_b64_tr_b16 v[238:239], v6 offset:13312
    ds_read_b64_tr_b16 v[240:241], v7 offset:12288
    ds_read_b64_tr_b16 v[242:243], v7 offset:13312
    s_waitcnt lgkmcnt(0)
    s_mul_i32 s35, s3, 100352
    s_add_u32 s35, s35, s32
    s_mov_b32 s97, s98
    s_lshl_b32 s27, s97, 11
    s_add_u32 m0, s27, s33
    s_mul_i32 s27, s97, 14336
    s_add_u32 s27, s27, s35
    buffer_load_dwordx4 v64, s[12:15], s27 offen lds
    buffer_load_dwordx4 v65, s[12:15], s27 offen offset:1024 lds
    s_add_u32 s97, s97, 1
    s_cmp_eq_u32 s97, 7
    s_cselect_b32 s97, 0, s97
    s_lshl_b32 s27, s97, 11
    s_add_u32 m0, s27, s33
    s_mul_i32 s27, s97, 14336
    s_add_u32 s27, s27, s35
    buffer_load_dwordx4 v64, s[12:15], s27 offen lds
    buffer_load_dwordx4 v65, s[12:15], s27 offen offset:1024 lds
    s_add_u32 s97, s97, 1
    s_cmp_eq_u32 s97, 7
    s_cselect_b32 s97, 0, s97
    s_lshl_b32 s27, s97, 11
    s_add_u32 m0, s27, s33
    s_mul_i32 s27, s97, 14336
    s_add_u32 s27, s27, s35
    buffer_load_dwordx4 v64, s[12:15], s27 offen lds
    s_waitcnt vmcnt(4)
    buffer_load_dwordx4 v65, s[12:15], s27 offen offset:1024 lds
    s_add_u32 s97, s97, 1
    s_cmp_eq_u32 s97, 7
    s_cselect_b32 s97, 0, s97
    s_lshl_b32 s27, s97, 11
    s_add_u32 m0, s27, s33
    s_mul_i32 s27, s97, 14336
    s_add_u32 s27, s27, s35
    s_waitcnt vmcnt(4)
    buffer_load_dwordx4 v64, s[12:15], s27 offen lds
    s_waitcnt vmcnt(4)
    buffer_load_dwordx4 v65, s[12:15], s27 offen offset:1024 lds
    s_add_u32 s97, s97, 1
    s_cmp_eq_u32 s97, 7
    s_cselect_b32 s97, 0, s97
    s_lshl_b32 s27, s97, 11
    s_add_u32 m0, s27, s33
    s_mul_i32 s27, s97, 14336
    s_add_u32 s27, s27, s35
    s_waitcnt vmcnt(4)
    buffer_load_dwordx4 v64, s[12:15], s27 offen lds
    s_waitcnt vmcnt(4)
    buffer_load_dwordx4 v65, s[12:15], s27 offen offset:1024 lds
    s_add_u32 s97, s97, 1
    s_cmp_eq_u32 s97, 7
    s_cselect_b32 s97, 0, s97
    s_lshl_b32 s27, s97, 11
    s_add_u32 m0, s27, s33
    s_mul_i32 s27, s97, 14336
    s_add_u32 s27, s27, s35
    s_waitcnt vmcnt(4)
    buffer_load_dwordx4 v64, s[12:15], s27 offen lds
    s_waitcnt vmcnt(4)
    buffer_load_dwordx4 v65, s[12:15], s27 offen offset:1024 lds
    s_add_u32 s97, s97, 1
    s_cmp_eq_u32 s97, 7
    s_cselect_b32 s97, 0, s97
    s_lshl_b32 s27, s97, 11
    s_add_u32 m0, s27, s33
    s_mul_i32 s27, s97, 14336
    s_add_u32 s27, s27, s35
    s_waitcnt vmcnt(4)
    buffer_load_dwordx4 v64, s[12:15], s27 offen lds
    s_waitcnt vmcnt(4)
    buffer_load_dwordx4 v65, s[12:15], s27 offen offset:1024 lds
    s_cmp_lg_u32 s3, 3
    s_cbranch_scc1 L_nz
    s_add_u32 m0, s33, 14336
    s_add_u32 s27, s35, 100352
    buffer_load_dwordx4 v64, s[12:15], s27 offen lds
L_nz:
    s_mul_i32 s77, s3, 57344
    s_lshl_b32 s76, s100, 7
    s_add_u32 s76, s76, s77
    s_lshl_b32 s69, s101, 7
    s_add_u32 s69, s69, s77
    s_lshl_b32 s77, s3, 11
    s_add_u32 s27, s99, 0
    s_cmp_ge_u32 s27, 7
    s_cselect_b32 s96, 7, 0
    s_sub_u32 s27, s27, s96
    s_mul_i32 s27, s27, 229376
    s_add_u32 m0, s77, 133120
    s_add_u32 s27, s27, s76
    s_waitcnt vmcnt(4)
    buffer_load_dwordx4 v24, s[64:67], s27 offen lds
    s_waitcnt vmcnt(4)
    buffer_load_dwordx4 v25, s[64:67], s27 offen offset:1024 lds
    s_add_u32 s27, s99, 1
    s_cmp_ge_u32 s27, 7
    s_cselect_b32 s96, 7, 0
    s_sub_u32 s27, s27, s96
    s_mul_i32 s27, s27, 229376
    s_add_u32 m0, s77, 141312
    s_add_u32 s27, s27, s76
    s_waitcnt vmcnt(4)
    buffer_load_dwordx4 v24, s[64:67], s27 offen lds
    s_waitcnt vmcnt(4)
    buffer_load_dwordx4 v25, s[64:67], s27 offen offset:1024 lds
    s_add_u32 s27, s99, 2
    s_cmp_ge_u32 s27, 7
    s_cselect_b32 s96, 7, 0
    s_sub_u32 s27, s27, s96
    s_mul_i32 s27, s27, 229376
    s_add_u32 m0, s77, 149504
    s_add_u32 s27, s27, s76
    s_waitcnt vmcnt(4)
    buffer_load_dwordx4 v24, s[64:67], s27 offen lds
    s_waitcnt vmcnt(4)
    buffer_load_dwordx4 v25, s[64:67], s27 offen offset:1024 lds
    s_bfe_u32 s35, s62, 0x10001
    s_lshl_b32 s35, s35, 2
    s_add_u32 s35, s35, s3
    s_mul_i32 s35, s35, 28672
    s_lshl_b32 s68, s100, 7
    s_add_u32 s68, s68, s35
    s_waitcnt vmcnt(4)
    buffer_load_dwordx4 v[20:23], v24, s[64:67], s68 offen
    s_add_u32 s68, s68, 229376
    s_waitcnt vmcnt(4)
    buffer_load_dwordx4 v[20:23], v24, s[64:67], s68 offen
    s_add_u32 s68, s68, 229376
    s_waitcnt vmcnt(4)
    buffer_load_dwordx4 v[20:23], v24, s[64:67], s68 offen
    s_add_u32 s68, s68, 229376
    s_waitcnt vmcnt(4)
    buffer_load_dwordx4 v[20:23], v24, s[64:67], s68 offen
    s_add_u32 s68, s68, 229376
    s_waitcnt vmcnt(4)
    buffer_load_dwordx4 v[20:23], v24, s[64:67], s68 offen
    s_add_u32 s68, s68, 229376
    s_waitcnt vmcnt(4)
    buffer_load_dwordx4 v[20:23], v24, s[64:67], s68 offen
    s_add_u32 s68, s68, 229376
    s_waitcnt vmcnt(4)
    buffer_load_dwordx4 v[20:23], v24, s[64:67], s68 offen
    s_lshl_b32 s68, s101, 7
    s_add_u32 s68, s68, s35
    s_waitcnt vmcnt(4)
    buffer_load_dwordx4 v[20:23], v24, s[64:67], s68 offen
    s_add_u32 s68, s68, 229376
    s_waitcnt vmcnt(4)
    buffer_load_dwordx4 v[20:23], v24, s[64:67], s68 offen
    s_add_u32 s68, s68, 229376
    s_waitcnt vmcnt(4)
    buffer_load_dwordx4 v[20:23], v24, s[64:67], s68 offen
    s_add_u32 s68, s68, 229376
    s_waitcnt vmcnt(4)
    buffer_load_dwordx4 v[20:23], v24, s[64:67], s68 offen
    s_add_u32 s68, s68, 229376
    s_waitcnt vmcnt(4)
    buffer_load_dwordx4 v[20:23], v24, s[64:67], s68 offen
    s_add_u32 s68, s68, 229376
    s_waitcnt vmcnt(4)
    buffer_load_dwordx4 v[20:23], v24, s[64:67], s68 offen
    s_add_u32 s68, s68, 229376
    s_waitcnt vmcnt(4)
    buffer_load_dwordx4 v[20:23], v24, s[64:67], s68 offen
    s_and_b32 s35, s62, 3
    s_mul_i32 s35, s35, 50176
    s_add_u32 s35, s35, s31
    s_add_u32 s35, s35, 200704
    s_waitcnt vmcnt(4)
    buffer_load_dwordx4 v[20:23], v64, s[8:11], s35 offen
    s_add_u32 s35, s35, 7168
    s_waitcnt vmcnt(4)
    buffer_load_dwordx4 v[20:23], v64, s[8:11], s35 offen
    s_add_u32 s35, s35, 7168
    s_waitcnt vmcnt(4)
    buffer_load_dwordx4 v[20:23], v64, s[8:11], s35 offen
    s_add_u32 s35, s35, 7168
    s_waitcnt vmcnt(4)
    buffer_load_dwordx4 v[20:23], v64, s[8:11], s35 offen
    s_add_u32 s35, s35, 7168
    s_waitcnt vmcnt(4)
    buffer_load_dwordx4 v[20:23], v64, s[8:11], s35 offen
    s_add_u32 s35, s35, 7168
    s_waitcnt vmcnt(4)
    buffer_load_dwordx4 v[20:23], v64, s[8:11], s35 offen
    s_add_u32 s35, s35, 7168
    s_waitcnt vmcnt(4)
    buffer_load_dwordx4 v[20:23], v64, s[8:11], s35 offen
    s_lshl_b32 s24, s30, 15
    s_lshl_b32 s25, s29, 12
    s_add_u32 s24, s24, s25
    s_add_u32 s24, s24, 0x600000
    s_lshl_b32 s35, s26, 15
    s_add_u32 s25, s25, s35
    s_lshr_b32 s73, s22, 1
    s_lshl_b32 s73, s73, 7
    s_add_u32 s73, s73, 0x1602000
    s_mov_b32 s75, 0
L_Bwait:
    s_barrier
    ds_read_b128 v[12:15], v11 offset:49152
    s_waitcnt lgkmcnt(0)
    v_or_b32 v12, v12, v13
    v_or3_b32 v12, v12, v14, v15
    s_nop 0
    v_readfirstlane_b32 s35, v12
    s_nop 3
    s_cmp_lg_u32 s35, 0
    s_cselect_b32 s35, 1, 0
    s_cmp_gt_u32 s35, s75
    s_cbranch_scc0 L_Bgo
    s_mov_b32 s75, 1
    s_barrier
    s_barrier
    s_barrier
    s_branch L_Bwait
L_Bgo:
    s_barrier
    s_barrier
    s_add_u32 s27, s99, 3
    s_cmp_ge_u32 s27, 7
    s_cselect_b32 s96, 7, 0
    s_sub_u32 s27, s27, s96
    s_mul_i32 s27, s27, 229376
    s_add_u32 m0, s77, 65536
    s_add_u32 s27, s27, s76
    buffer_load_dwordx4 v24, s[64:67], s27 offen lds
    buffer_load_dwordx4 v25, s[64:67], s27 offen offset:1024 lds
    s_add_u32 s27, s99, 4
    s_cmp_ge_u32 s27, 7
    s_cselect_b32 s96, 7, 0
    s_sub_u32 s27, s27, s96
    s_mul_i32 s27, s27, 229376
    s_add_u32 m0, s77, 73728
    s_add_u32 s27, s27, s76
    buffer_load_dwordx4 v24, s[64:67], s27 offen lds
    buffer_load_dwordx4 v25, s[64:67], s27 offen offset:1024 lds
    s_add_u32 s27, s99, 5
    s_cmp_ge_u32 s27, 7
    s_cselect_b32 s96, 7, 0
    s_sub_u32 s27, s27, s96
    s_mul_i32 s27, s27, 229376
    s_add_u32 m0, s77, 81920
    s_add_u32 s27, s27, s76
    buffer_load_dwordx4 v24, s[64:67], s27 offen lds
    buffer_load_dwordx4 v25, s[64:67], s27 offen offset:1024 lds
    s_add_u32 s27, s99, 6
    s_cmp_ge_u32 s27, 7
    s_cselect_b32 s96, 7, 0
    s_sub_u32 s27, s27, s96
    s_mul_i32 s27, s27, 229376
    s_add_u32 m0, s77, 90112
    s_add_u32 s27, s27, s76
    buffer_load_dwordx4 v24, s[64:67], s27 offen lds
    buffer_load_dwordx4 v25, s[64:67], s27 offen offset:1024 lds
    s_add_u32 s27, s99, 0
    s_cmp_ge_u32 s27, 7
    s_cselect_b32 s96, 7, 0
    s_sub_u32 s27, s27, s96
    s_mul_i32 s27, s27, 229376
    s_add_u32 m0, s77, 98304
    s_add_u32 s27, s27, s69
    buffer_load_dwordx4 v24, s[64:67], s27 offen lds
    buffer_load_dwordx4 v25, s[64:67], s27 offen offset:1024 lds
    s_add_u32 s27, s99, 1
    s_cmp_ge_u32 s27, 7
    s_cselect_b32 s96, 7, 0
    s_sub_u32 s27, s27, s96
    s_mul_i32 s27, s27, 229376
    s_add_u32 m0, s77, 106496
    s_add_u32 s27, s27, s69
    buffer_load_dwordx4 v24, s[64:67], s27 offen lds
    buffer_load_dwordx4 v25, s[64:67], s27 offen offset:1024 lds
    s_add_u32 s27, s99, 2
    s_cmp_ge_u32 s27, 7
    s_cselect_b32 s96, 7, 0
    s_sub_u32 s27, s27, s96
    s_mul_i32 s27, s27, 229376
    s_add_u32 m0, s77, 114688
    s_add_u32 s27, s27, s69
    buffer_load_dwordx4 v24, s[64:67], s27 offen lds
    buffer_load_dwordx4 v25, s[64:67], s27 offen offset:1024 lds
    s_add_u32 s27, s99, 3
    s_cmp_ge_u32 s27, 7
    s_cselect_b32 s96, 7, 0
    s_sub_u32 s27, s27, s96
    s_mul_i32 s27, s27, 229376
    s_add_u32 m0, s77, 122880
    s_add_u32 s27, s27, s69
    buffer_load_dwordx4 v24, s[64:67], s27 offen lds
    buffer_load_dwordx4 v25, s[64:67], s27 offen offset:1024 lds
    s_cmp_lg_u32 s3, 0
    s_cbranch_scc1 L_nopoll
    s_mov_b32 s34, 100000
poll_5:
    buffer_load_dword v8, v26, s[16:19], s73 offen sc1
    s_sub_u32 s34, s34, 1
    s_cbranch_scc1 polle_6
    s_waitcnt vmcnt(0)
    v_cmp_ne_u32 vcc, s60, v8
    s_cbranch_vccnz poll_5
polle_6:
    s_waitcnt vmcnt(0)
L_nopoll:
    s_barrier
    s_add_u32 m0, s25, 0
    s_add_u32 s27, s24, 0
    buffer_load_dwordx4 v2, s[16:19], s27 offen offset:0 lds
    buffer_load_dwordx4 v2, s[16:19], s27 offen offset:1024 lds
    buffer_load_dwordx4 v2, s[16:19], s27 offen offset:2048 lds
    buffer_load_dwordx4 v2, s[16:19], s27 offen offset:3072 lds
    s_add_u32 m0, s25, 8192
    s_add_u32 s27, s24, 8192
    buffer_load_dwordx4 v2, s[16:19], s27 offen offset:0 lds
    buffer_load_dwordx4 v2, s[16:19], s27 offen offset:1024 lds
    buffer_load_dwordx4 v2, s[16:19], s27 offen offset:2048 lds
    buffer_load_dwordx4 v2, s[16:19], s27 offen offset:3072 lds
    s_add_u32 m0, s25, 16384
    s_add_u32 s27, s24, 16384
    buffer_load_dwordx4 v2, s[16:19], s27 offen offset:0 lds
    buffer_load_dwordx4 v2, s[16:19], s27 offen offset:1024 lds
    buffer_load_dwordx4 v2, s[16:19], s27 offen offset:2048 lds
    buffer_load_dwordx4 v2, s[16:19], s27 offen offset:3072 lds
    s_add_u32 m0, s25, 24576
    s_add_u32 s27, s24, 24576
    buffer_load_dwordx4 v2, s[16:19], s27 offen offset:0 lds
    buffer_load_dwordx4 v2, s[16:19], s27 offen offset:1024 lds
    buffer_load_dwordx4 v2, s[16:19], s27 offen offset:2048 lds
    buffer_load_dwordx4 v2, s[16:19], s27 offen offset:3072 lds
    s_waitcnt vmcnt(12)
    s_barrier
    s_waitcnt vmcnt(8)
    s_barrier
    s_add_u32 s27, s99, 4
    s_cmp_ge_u32 s27, 7
    s_cselect_b32 s96, 7, 0
    s_sub_u32 s27, s27, s96
    s_mul_i32 s27, s27, 229376
    s_add_u32 m0, s77, 0
    s_add_u32 s27, s27, s69
    buffer_load_dwordx4 v24, s[64:67], s27 offen lds
    buffer_load_dwordx4 v25, s[64:67], s27 offen offset:1024 lds
    s_waitcnt vmcnt(6)
    s_barrier
    s_add_u32 s27, s99, 5
    s_cmp_ge_u32 s27, 7
    s_cselect_b32 s96, 7, 0
    s_sub_u32 s27, s27, s96
    s_mul_i32 s27, s27, 229376
    s_add_u32 m0, s77, 8192
    s_add_u32 s27, s27, s69
    buffer_load_dwordx4 v24, s[64:67], s27 offen lds
    buffer_load_dwordx4 v25, s[64:67], s27 offen offset:1024 lds
    s_waitcnt vmcnt(4)
    s_barrier
    s_add_u32 s27, s99, 6
    s_cmp_ge_u32 s27, 7
    s_cselect_b32 s96, 7, 0
    s_sub_u32 s27, s27, s96
    s_mul_i32 s27, s27, 229376
    s_add_u32 m0, s77, 16384
    s_add_u32 s27, s27, s69
    buffer_load_dwordx4 v24, s[64:67], s27 offen lds
    buffer_load_dwordx4 v25, s[64:67], s27 offen offset:1024 lds
    s_barrier
    s_mul_i32 s20, s3, 10240
    s_add_u32 s20, s20, 24576
    s_setprio 0
    s_and_b32 s21, s3, 1
    s_mul_i32 s21, s21, 14336
    s_mov_b32 s27, 65536
    s_cmp_lt_u32 s3, 2
    s_cselect_b32 s27, 133120, s27
    s_add_u32 s21, s21, s27
    s_lshl_b32 s78, s3, 12
    s_add_u32 s78, s78, 98304
    v_add_u32 v6, s20, v4
    v_add_u32 v7, s20, v5
    v_add_u32 v244, s78, v4
    v_add_u32 v245, s78, v5
    v_add_u32 v4, s21, v4
    v_add_u32 v5, s21, v5
    v_and_b32 v12, 31, v1
    v_lshrrev_b32 v8, 5, v1
    v_and_b32 v0, 15, v1
    v_min_u32 v0, 13, v0
    v_bfe_u32 v10, v1, 4, 1
    v_lshl_add_u32 v18, v10, 4, v0
    v_lshlrev_b32 v18, 2, v18
    v_lshlrev_b32 v0, 2, v0
    s_and_b32 s27, s30, 3
    s_lshl_b32 s27, s27, 7
    s_add_u32 s27, s27, 163328
    v_lshl_add_u32 v3, v12, 2, s27
    s_xor_b32 s33, s30, 1
    s_mul_i32 s24, s30, 114688
    s_add_u32 s24, s24, 0xc00000
    s_mul_i32 s25, s33, 114688
    s_add_u32 s25, s25, 0xc00000
    s_mul_i32 s27, s3, 28672
    s_add_u32 s24, s24, s27
    s_add_u32 s25, s25, s27
    s_add_u32 s36, s56, s24
    s_addc_u32 s37, s57, 0
    s_add_u32 s38, s56, s25
    s_addc_u32 s39, s57, 0
    v_lshrrev_b32 v11, 1, v12
    v_lshlrev_b32 v13, 1, v8
    v_sub_u32 v11, v11, v13
    v_and_b32 v13, 1, v1
    v_lshlrev_b32 v13, 4, v13
    v_mov_b32 v14, 0x3f80
    v_lshlrev_b32 v13, v13, v14
    v_mul_u32_u24 v19, 896, v12
    v_lshl_add_u32 v19, v8, 4, v19
    v_lshlrev_b32 v15, 1, v12
    v_cmp_eq_u32 vcc, 0, v11
    s_nop 1
    v_cndmask_b32 v48, 0, v13, vcc
    v_cmp_eq_u32 vcc, 1, v11
    s_nop 1
    v_cndmask_b32 v49, 0, v13, vcc
    v_cmp_eq_u32 vcc, 4, v11
    s_nop 1
    v_cndmask_b32 v50, 0, v13, vcc
    v_cmp_eq_u32 vcc, 5, v11
    s_nop 1
    v_cndmask_b32 v51, 0, v13, vcc
    v_cmp_eq_u32 vcc, 8, v11
    s_nop 1
    v_cndmask_b32 v52, 0, v13, vcc
    v_cmp_eq_u32 vcc, 9, v11
    s_nop 1
    v_cndmask_b32 v53, 0, v13, vcc
    v_cmp_eq_u32 vcc, 12, v11
    s_nop 1
    v_cndmask_b32 v54, 0, v13, vcc
    v_cmp_eq_u32 vcc, 13, v11
    s_nop 1
    v_cndmask_b32 v55, 0, v13, vcc
    v_mov_b32 v40, 0x3f80
    v_mov_b32 v41, 0
    v_mov_b32 v37, 0
    v_mov_b32 v42, 0
    v_mov_b32 v38, 0
    v_mov_b32 v43, 0
    v_mov_b32 v39, 0
    s_xor_b32 s27, s3, 1
    s_mul_i32 s27, s27, 12288
    s_add_u32 s27, s27, 0
    v_add_u32 v44, s27, v2
    s_xor_b32 s27, s3, 2
    s_mul_i32 s27, s27, 12288
    s_add_u32 s27, s27, 4096
    v_add_u32 v45, s27, v2
    s_xor_b32 s27, s3, 3
    s_mul_i32 s27, s27, 12288
    s_add_u32 s27, s27, 8192
    v_add_u32 v46, s27, v2
    s_mov_b32 s12, s50
    s_mov_b32 s13, s51
    s_mov_b32 s14, 0x380
    s_mov_b32 s15, 0x00020000
    s_mul_i32 s27, s3, 12288
    v_add_u32 v47, s27, v2
    s_mul_i32 s71, s30, 28672
    s_lshl_b32 s35, s72, 6
    s_add_u32 s71, s71, s35
    s_waitcnt vmcnt(0)
    s_barrier
    s_barrier
    ds_read_b32 v85, v3
    buffer_load_ushort v36, v15, s[12:15], s35 offen
    buffer_load_dwordx4 v[28:31], v2, s[16:19], s70 offen
    buffer_load_dwordx4 v[32:35], v2, s[16:19], s70 offen offset:1024
    s_add_u32 m0, s20, 0
    s_add_u32 s27, s31, 200704
    buffer_load_dwordx4 v64, s[8:11], s27 offen offset:0 lds
    buffer_load_dwordx4 v65, s[8:11], s27 offen offset:1024 lds
    buffer_load_dwordx4 v66, s[8:11], s27 offen offset:2048 lds
    buffer_load_dwordx4 v67, s[8:11], s27 offen offset:3072 lds
    s_add_u32 m0, s20, 4096
    s_add_u32 s27, s31, 229376
    buffer_load_dwordx4 v64, s[8:11], s27 offen offset:0 lds
    buffer_load_dwordx4 v65, s[8:11], s27 offen offset:1024 lds
    buffer_load_dwordx4 v66, s[8:11], s27 offen offset:2048 lds
    buffer_load_dwordx4 v67, s[8:11], s27 offen offset:3072 lds
    s_add_u32 m0, s20, 8192
    s_add_u32 s27, s31, 258048
    buffer_load_dwordx4 v64, s[8:11], s27 offen offset:0 lds
    buffer_load_dwordx4 v65, s[8:11], s27 offen offset:1024 lds
    s_add_u32 m0, s21, 0
    s_add_u32 s27, s31, 272384
    buffer_load_dwordx4 v64, s[8:11], s27 offen offset:0 lds
    buffer_load_dwordx4 v65, s[8:11], s27 offen offset:1024 lds
    buffer_load_dwordx4 v66, s[8:11], s27 offen offset:2048 lds
    buffer_load_dwordx4 v67, s[8:11], s27 offen offset:3072 lds
    s_add_u32 m0, s21, 4096
    s_add_u32 s27, s31, 301056
    buffer_load_dwordx4 v64, s[8:11], s27 offen offset:0 lds
    buffer_load_dwordx4 v65, s[8:11], s27 offen offset:1024 lds
    buffer_load_dwordx4 v66, s[8:11], s27 offen offset:2048 lds
    buffer_load_dwordx4 v67, s[8:11], s27 offen offset:3072 lds
    s_add_u32 m0, s21, 8192
    s_add_u32 s27, s31, 329728
    buffer_load_dwordx4 v64, s[8:11], s27 offen offset:0 lds
    buffer_load_dwordx4 v65, s[8:11], s27 offen offset:1024 lds
    buffer_load_dwordx4 v66, s[8:11], s27 offen offset:2048 lds
    buffer_load_dwordx4 v67, s[8:11], s27 offen offset:3072 lds
    s_add_u32 m0, s21, 12288
    s_add_u32 s27, s31, 358400
    buffer_load_dwordx4 v64, s[8:11], s27 offen offset:0 lds
    buffer_load_dwordx4 v65, s[8:11], s27 offen offset:1024 lds
    s_mov_b32 s64, s52
    s_mov_b32 s65, s53
    s_mov_b32 s66, 0x1c0000
    s_mov_b32 s67, 0x00020000
    s_lshl_b32 s73, s22, 7
    s_add_u32 s73, s73, 0x1606000
    s_add_u32 s79, s73, 0x4000
    s_waitcnt vmcnt(24)
    s_mov_b32 exec_lo, 0
    v_mov_b32 v36, 0
    s_mov_b32 exec_lo, -1
    s_nop 1
    v_mfma_f32_32x32x16_bf16 v[68:83], v[36:39], v[40:43], 0
    v_mfma_f32_32x32x16_bf16 v[68:83], v[48:51], v[28:31], v[68:83]
    v_mfma_f32_32x32x16_bf16 v[68:83], v[52:55], v[32:35], v[68:83]
    s_waitcnt lgkmcnt(0)
    v_rsq_f32 v16, v85
    s_nop 8
    v_mul_f32 v16, v16, v16
    v_mul_f32 v68, v85, v68
    v_mul_f32 v69, v85, v69
    v_mul_f32 v70, v85, v70
    v_mul_f32 v71, v85, v71
    v_mul_f32 v72, v85, v72
    v_mul_f32 v73, v85, v73
    v_mul_f32 v74, v85, v74
    v_mul_f32 v75, v85, v75
    v_mul_f32 v76, v85, v76
    v_mul_f32 v77, v85, v77
    v_mul_f32 v78, v85, v78
    v_mul_f32 v79, v85, v79
    v_mul_f32 v80, v85, v80
    v_mul_f32 v81, v85, v81
    v_mul_f32 v82, v85, v82
    v_mul_f32 v83, v85, v83
    s_mov_b32 s34, 100000
poll_7:
    buffer_load_dword v8, v18, s[16:19], s73 offen sc1
    s_sub_u32 s34, s34, 1
    s_cbranch_scc1 polle_8
    s_waitcnt vmcnt(0)
    v_cmp_ne_u32 vcc, s60, v8
    s_cbranch_vccnz poll_7
polle_8:
    s_waitcnt vmcnt(0)
    buffer_load_dwordx4 v[20:23], v2, s[16:19], s24 offen offset:0
    buffer_load_dwordx4 v[24:27], v2, s[16:19], s25 offen offset:0
    buffer_load_dwordx4 v[28:31], v2, s[16:19], s24 offen offset:1024
    buffer_load_dwordx4 v[32:35], v2, s[16:19], s25 offen offset:1024
    buffer_load_dwordx4 v[36:39], v2, s[16:19], s24 offen offset:2048
    buffer_load_dwordx4 v[40:43], v2, s[16:19], s25 offen offset:2048
    buffer_load_dwordx4 v[48:51], v2, s[16:19], s24 offen offset:3072
    buffer_load_dwordx4 v[52:55], v2, s[16:19], s25 offen offset:3072
    s_add_u32 s24, s24, 4096
    s_add_u32 s25, s25, 4096
    s_waitcnt vmcnt(6)
    v_mfma_f32_32x32x16_bf16 v[68:83], v[132:135], v[20:23], v[68:83]
    buffer_load_dwordx4 v[56:59], v2, s[16:19], s24 offen offset:0
    v_mfma_f32_32x32x16_bf16 v[84:99], v[136:139], v[20:23], 0
    buffer_load_dwordx4 v[60:63], v2, s[16:19], s25 offen offset:0
    v_mfma_f32_32x32x16_bf16 v[100:115], v[132:135], v[24:27], 0
    v_mfma_f32_32x32x16_bf16 v[116:131], v[136:139], v[24:27], 0
    s_waitcnt vmcnt(6)
    v_mfma_f32_32x32x16_bf16 v[68:83], v[140:143], v[28:31], v[68:83]
    buffer_load_dwordx4 v[20:23], v2, s[16:19], s24 offen offset:1024
    v_mfma_f32_32x32x16_bf16 v[84:99], v[144:147], v[28:31], v[84:99]
    buffer_load_dwordx4 v[24:27], v2, s[16:19], s25 offen offset:1024
    v_mfma_f32_32x32x16_bf16 v[100:115], v[140:143], v[32:35], v[100:115]
    v_mfma_f32_32x32x16_bf16 v[116:131], v[144:147], v[32:35], v[116:131]
    s_waitcnt vmcnt(6)
    v_mfma_f32_32x32x16_bf16 v[68:83], v[148:151], v[36:39], v[68:83]
    buffer_load_dwordx4 v[28:31], v2, s[16:19], s24 offen offset:2048
    v_mfma_f32_32x32x16_bf16 v[84:99], v[152:155], v[36:39], v[84:99]
    buffer_load_dwordx4 v[32:35], v2, s[16:19], s25 offen offset:2048
    v_mfma_f32_32x32x16_bf16 v[100:115], v[148:151], v[40:43], v[100:115]
    v_mfma_f32_32x32x16_bf16 v[116:131], v[152:155], v[40:43], v[116:131]
    s_waitcnt vmcnt(6)
    v_mfma_f32_32x32x16_bf16 v[68:83], v[156:159], v[48:51], v[68:83]
    buffer_load_dwordx4 v[36:39], v2, s[16:19], s24 offen offset:3072
    v_mfma_f32_32x32x16_bf16 v[84:99], v[160:163], v[48:51], v[84:99]
    buffer_load_dwordx4 v[40:43], v2, s[16:19], s25 offen offset:3072
    s_add_u32 s24, s24, 4096
    s_add_u32 s25, s25, 4096
    v_mfma_f32_32x32x16_bf16 v[100:115], v[156:159], v[52:55], v[100:115]
    v_mfma_f32_32x32x16_bf16 v[116:131], v[160:163], v[52:55], v[116:131]
    s_waitcnt vmcnt(6)
    v_mfma_f32_32x32x16_bf16 v[68:83], v[164:167], v[56:59], v[68:83]
    buffer_load_dwordx4 v[48:51], v2, s[16:19], s24 offen offset:0
    v_mfma_f32_32x32x16_bf16 v[84:99], v[168:171], v[56:59], v[84:99]
    buffer_load_dwordx4 v[52:55], v2, s[16:19], s25 offen offset:0
    v_mfma_f32_32x32x16_bf16 v[100:115], v[164:167], v[60:63], v[100:115]
    v_mfma_f32_32x32x16_bf16 v[116:131], v[168:171], v[60:63], v[116:131]
    s_waitcnt vmcnt(6)
    v_mfma_f32_32x32x16_bf16 v[68:83], v[172:175], v[20:23], v[68:83]
    buffer_load_dwordx4 v[56:59], v2, s[16:19], s24 offen offset:1024
    v_mfma_f32_32x32x16_bf16 v[84:99], v[176:179], v[20:23], v[84:99]
    buffer_load_dwordx4 v[60:63], v2, s[16:19], s25 offen offset:1024
    v_mfma_f32_32x32x16_bf16 v[100:115], v[172:175], v[24:27], v[100:115]
    buffer_load_dwordx4 v[164:167], v2, s[16:19], s24 offen offset:2048
    v_mfma_f32_32x32x16_bf16 v[116:131], v[176:179], v[24:27], v[116:131]
    buffer_load_dwordx4 v[168:171], v2, s[16:19], s25 offen offset:2048
    s_waitcnt vmcnt(8)
    v_mfma_f32_32x32x16_bf16 v[68:83], v[180:183], v[28:31], v[68:83]
    buffer_load_dwordx4 v[20:23], v2, s[16:19], s24 offen offset:3072
    v_mfma_f32_32x32x16_bf16 v[84:99], v[184:187], v[28:31], v[84:99]
    buffer_load_dwordx4 v[24:27], v2, s[16:19], s25 offen offset:3072
    s_add_u32 s24, s24, 4096
    s_add_u32 s25, s25, 4096
    v_mfma_f32_32x32x16_bf16 v[100:115], v[180:183], v[32:35], v[100:115]
    buffer_load_dwordx4 v[172:175], v2, s[16:19], s24 offen offset:0
    v_mfma_f32_32x32x16_bf16 v[116:131], v[184:187], v[32:35], v[116:131]
    buffer_load_dwordx4 v[176:179], v2, s[16:19], s25 offen offset:0
    s_waitcnt vmcnt(10)
    v_mfma_f32_32x32x16_bf16 v[68:83], v[188:191], v[36:39], v[68:83]
    buffer_load_dwordx4 v[28:31], v2, s[16:19], s24 offen offset:1024
    v_mfma_f32_32x32x16_bf16 v[84:99], v[192:195], v[36:39], v[84:99]
    buffer_load_dwordx4 v[32:35], v2, s[16:19], s25 offen offset:1024
    v_mfma_f32_32x32x16_bf16 v[100:115], v[188:191], v[40:43], v[100:115]
    buffer_load_dwordx4 v[180:183], v2, s[16:19], s24 offen offset:2048
    v_mfma_f32_32x32x16_bf16 v[116:131], v[192:195], v[40:43], v[116:131]
    buffer_load_dwordx4 v[184:187], v2, s[16:19], s25 offen offset:2048
    s_waitcnt vmcnt(12)
    s_barrier
    s_add_u32 m0, s78, 0
    s_add_u32 s27, s31, 372736
    buffer_load_dwordx4 v64, s[8:11], s27 offen offset:0 lds
    buffer_load_dwordx4 v65, s[8:11], s27 offen offset:1024 lds
    buffer_load_dwordx4 v66, s[8:11], s27 offen offset:2048 lds
    buffer_load_dwordx4 v67, s[8:11], s27 offen offset:3072 lds
    v_mfma_f32_32x32x16_bf16 v[68:83], v[196:199], v[48:51], v[68:83]
    buffer_load_dwordx4 v[36:39], v2, s[16:19], s24 offen offset:3072
    v_mfma_f32_32x32x16_bf16 v[84:99], v[200:203], v[48:51], v[84:99]
    buffer_load_dwordx4 v[40:43], v2, s[16:19], s25 offen offset:3072
    s_add_u32 s24, s24, 4096
    s_add_u32 s25, s25, 4096
    v_mfma_f32_32x32x16_bf16 v[100:115], v[196:199], v[52:55], v[100:115]
    buffer_load_dwordx4 v[188:191], v2, s[16:19], s24 offen offset:0
    v_mfma_f32_32x32x16_bf16 v[116:131], v[200:203], v[52:55], v[116:131]
    buffer_load_dwordx4 v[192:195], v2, s[16:19], s25 offen offset:0
    s_waitcnt vmcnt(18)
    v_mfma_f32_32x32x16_bf16 v[68:83], v[204:207], v[56:59], v[68:83]
    buffer_load_dwordx4 v[48:51], v2, s[16:19], s24 offen offset:1024
    v_mfma_f32_32x32x16_bf16 v[84:99], v[208:211], v[56:59], v[84:99]
    buffer_load_dwordx4 v[52:55], v2, s[16:19], s25 offen offset:1024
    v_mfma_f32_32x32x16_bf16 v[100:115], v[204:207], v[60:63], v[100:115]
    v_mfma_f32_32x32x16_bf16 v[116:131], v[208:211], v[60:63], v[116:131]
    s_waitcnt vmcnt(18)
    v_mfma_f32_32x32x16_bf16 v[68:83], v[212:215], v[164:167], v[68:83]
    buffer_load_dwordx4 v[196:199], v2, s[16:19], s24 offen offset:2048
    v_mfma_f32_32x32x16_bf16 v[84:99], v[216:219], v[164:167], v[84:99]
    buffer_load_dwordx4 v[200:203], v2, s[16:19], s25 offen offset:2048
    v_mfma_f32_32x32x16_bf16 v[100:115], v[212:215], v[168:171], v[100:115]
    v_mfma_f32_32x32x16_bf16 v[116:131], v[216:219], v[168:171], v[116:131]
    s_waitcnt vmcnt(18)
    v_mfma_f32_32x32x16_bf16 v[68:83], v[220:223], v[20:23], v[68:83]
    buffer_load_dwordx4 v[56:59], v2, s[16:19], s24 offen offset:3072
    v_mfma_f32_32x32x16_bf16 v[84:99], v[224:227], v[20:23], v[84:99]
    buffer_load_dwordx4 v[60:63], v2, s[16:19], s25 offen offset:3072
    s_add_u32 s24, s24, 4096
    s_add_u32 s25, s25, 4096
    v_mfma_f32_32x32x16_bf16 v[100:115], v[220:223], v[24:27], v[100:115]
    v_mfma_f32_32x32x16_bf16 v[116:131], v[224:227], v[24:27], v[116:131]
    s_waitcnt vmcnt(18)
    ds_read_b64_tr_b16 v[148:149], v6 offset:0
    ds_read_b64_tr_b16 v[150:151], v6 offset:1024
    ds_read_b64_tr_b16 v[152:153], v7 offset:0
    ds_read_b64_tr_b16 v[154:155], v7 offset:1024
    v_mfma_f32_32x32x16_bf16 v[68:83], v[228:231], v[172:175], v[68:83]
    buffer_load_dwordx4 v[204:207], v2, s[16:19], s24 offen offset:0
    v_mfma_f32_32x32x16_bf16 v[84:99], v[232:235], v[172:175], v[84:99]
    buffer_load_dwordx4 v[208:211], v2, s[16:19], s25 offen offset:0
    v_mfma_f32_32x32x16_bf16 v[100:115], v[228:231], v[176:179], v[100:115]
    v_mfma_f32_32x32x16_bf16 v[116:131], v[232:235], v[176:179], v[116:131]
    s_waitcnt vmcnt(18)
    ds_read_b64_tr_b16 v[156:157], v6 offset:2048
    ds_read_b64_tr_b16 v[158:159], v6 offset:3072
    ds_read_b64_tr_b16 v[160:161], v7 offset:2048
    ds_read_b64_tr_b16 v[162:163], v7 offset:3072
    v_mfma_f32_32x32x16_bf16 v[68:83], v[236:239], v[28:31], v[68:83]
    buffer_load_dwordx4 v[164:167], v2, s[16:19], s24 offen offset:1024
    v_mfma_f32_32x32x16_bf16 v[84:99], v[240:243], v[28:31], v[84:99]
    buffer_load_dwordx4 v[168:171], v2, s[16:19], s25 offen offset:1024
    v_mfma_f32_32x32x16_bf16 v[100:115], v[236:239], v[32:35], v[100:115]
    v_mfma_f32_32x32x16_bf16 v[116:131], v[240:243], v[32:35], v[116:131]
    s_waitcnt vmcnt(18)
    ds_read_b64_tr_b16 v[132:133], v6 offset:4096
    ds_read_b64_tr_b16 v[134:135], v6 offset:5120
    ds_read_b64_tr_b16 v[136:137], v7 offset:4096
    ds_read_b64_tr_b16 v[138:139], v7 offset:5120
    s_waitcnt lgkmcnt(8)
    v_mfma_f32_32x32x16_bf16 v[68:83], v[148:151], v[180:183], v[68:83]
    buffer_load_dwordx4 v[212:215], v2, s[16:19], s24 offen offset:2048
    v_mfma_f32_32x32x16_bf16 v[84:99], v[152:155], v[180:183], v[84:99]
    buffer_load_dwordx4 v[216:219], v2, s[16:19], s25 offen offset:2048
    v_mfma_f32_32x32x16_bf16 v[100:115], v[148:151], v[184:187], v[100:115]
    v_mfma_f32_32x32x16_bf16 v[116:131], v[152:155], v[184:187], v[116:131]
    s_waitcnt vmcnt(14)
    ds_read_b64_tr_b16 v[140:141], v6 offset:6144
    ds_read_b64_tr_b16 v[142:143], v6 offset:7168
    ds_read_b64_tr_b16 v[144:145], v7 offset:6144
    ds_read_b64_tr_b16 v[146:147], v7 offset:7168
    s_waitcnt lgkmcnt(8)
    v_mfma_f32_32x32x16_bf16 v[68:83], v[156:159], v[36:39], v[68:83]
    buffer_load_dwordx4 v[20:23], v2, s[16:19], s24 offen offset:3072
    v_mfma_f32_32x32x16_bf16 v[84:99], v[160:163], v[36:39], v[84:99]
    buffer_load_dwordx4 v[24:27], v2, s[16:19], s25 offen offset:3072
    s_add_u32 s24, s24, 4096
    s_add_u32 s25, s25, 4096
    v_mfma_f32_32x32x16_bf16 v[100:115], v[156:159], v[40:43], v[100:115]
    v_mfma_f32_32x32x16_bf16 v[116:131], v[160:163], v[40:43], v[116:131]
    s_waitcnt vmcnt(14)
    ds_read_b64_tr_b16 v[148:149], v6 offset:8192
    ds_read_b64_tr_b16 v[150:151], v6 offset:9216
    ds_read_b64_tr_b16 v[152:153], v7 offset:8192
    ds_read_b64_tr_b16 v[154:155], v7 offset:9216
    s_waitcnt lgkmcnt(8)
    v_mfma_f32_32x32x16_bf16 v[68:83], v[132:135], v[188:191], v[68:83]
    buffer_load_dwordx4 v[220:223], v2, s[16:19], s24 offen offset:0
    v_mfma_f32_32x32x16_bf16 v[84:99], v[136:139], v[188:191], v[84:99]
    buffer_load_dwordx4 v[224:227], v2, s[16:19], s25 offen offset:0
    v_mfma_f32_32x32x16_bf16 v[100:115], v[132:135], v[192:195], v[100:115]
    v_mfma_f32_32x32x16_bf16 v[116:131], v[136:139], v[192:195], v[116:131]
    s_waitcnt vmcnt(14)
    ds_read_b64_tr_b16 v[156:157], v4 offset:0
    ds_read_b64_tr_b16 v[158:159], v4 offset:1024
    ds_read_b64_tr_b16 v[160:161], v5 offset:0
    ds_read_b64_tr_b16 v[162:163], v5 offset:1024
    s_waitcnt lgkmcnt(8)
    v_mfma_f32_32x32x16_bf16 v[68:83], v[140:143], v[48:51], v[68:83]
    buffer_load_dwordx4 v[172:175], v2, s[16:19], s24 offen offset:1024
    v_mfma_f32_32x32x16_bf16 v[84:99], v[144:147], v[48:51], v[84:99]
    buffer_load_dwordx4 v[176:179], v2, s[16:19], s25 offen offset:1024
    v_mfma_f32_32x32x16_bf16 v[100:115], v[140:143], v[52:55], v[100:115]
    v_mfma_f32_32x32x16_bf16 v[116:131], v[144:147], v[52:55], v[116:131]
    s_waitcnt vmcnt(14)
    ds_read_b64_tr_b16 v[132:133], v4 offset:2048
    ds_read_b64_tr_b16 v[134:135], v4 offset:3072
    ds_read_b64_tr_b16 v[136:137], v5 offset:2048
    ds_read_b64_tr_b16 v[138:139], v5 offset:3072
    s_waitcnt lgkmcnt(8)
    v_mfma_f32_32x32x16_bf16 v[68:83], v[148:151], v[196:199], v[68:83]
    buffer_load_dwordx4 v[228:231], v2, s[16:19], s24 offen offset:2048
    v_mfma_f32_32x32x16_bf16 v[84:99], v[152:155], v[196:199], v[84:99]
    buffer_load_dwordx4 v[232:235], v2, s[16:19], s25 offen offset:2048
    v_mfma_f32_32x32x16_bf16 v[100:115], v[148:151], v[200:203], v[100:115]
    v_mfma_f32_32x32x16_bf16 v[116:131], v[152:155], v[200:203], v[116:131]
    s_waitcnt vmcnt(14)
    ds_read_b64_tr_b16 v[140:141], v4 offset:4096
    ds_read_b64_tr_b16 v[142:143], v4 offset:5120
    ds_read_b64_tr_b16 v[144:145], v5 offset:4096
    ds_read_b64_tr_b16 v[146:147], v5 offset:5120
    s_waitcnt lgkmcnt(8)
    v_mfma_f32_32x32x16_bf16 v[68:83], v[156:159], v[56:59], v[68:83]
    buffer_load_dwordx4 v[28:31], v2, s[16:19], s24 offen offset:3072
    v_mfma_f32_32x32x16_bf16 v[84:99], v[160:163], v[56:59], v[84:99]
    buffer_load_dwordx4 v[32:35], v2, s[16:19], s25 offen offset:3072
    v_mfma_f32_32x32x16_bf16 v[100:115], v[156:159], v[60:63], v[100:115]
    v_mfma_f32_32x32x16_bf16 v[116:131], v[160:163], v[60:63], v[116:131]
    s_waitcnt vmcnt(14)
    ds_read_b64_tr_b16 v[148:149], v4 offset:6144
    ds_read_b64_tr_b16 v[150:151], v4 offset:7168
    ds_read_b64_tr_b16 v[152:153], v5 offset:6144
    ds_read_b64_tr_b16 v[154:155], v5 offset:7168
    s_waitcnt lgkmcnt(8)
    v_mfma_f32_32x32x16_bf16 v[68:83], v[132:135], v[204:207], v[68:83]
    v_mfma_f32_32x32x16_bf16 v[84:99], v[136:139], v[204:207], v[84:99]
    v_mfma_f32_32x32x16_bf16 v[100:115], v[132:135], v[208:211], v[100:115]
    v_mfma_f32_32x32x16_bf16 v[116:131], v[136:139], v[208:211], v[116:131]
    s_waitcnt vmcnt(12)
    s_barrier
    ds_read_b64_tr_b16 v[156:157], v4 offset:8192
    ds_read_b64_tr_b16 v[158:159], v4 offset:9216
    ds_read_b64_tr_b16 v[160:161], v5 offset:8192
    ds_read_b64_tr_b16 v[162:163], v5 offset:9216
    s_waitcnt lgkmcnt(8)
    v_mfma_f32_32x32x16_bf16 v[68:83], v[140:143], v[164:167], v[68:83]
    v_mfma_f32_32x32x16_bf16 v[84:99], v[144:147], v[164:167], v[84:99]
    v_mfma_f32_32x32x16_bf16 v[100:115], v[140:143], v[168:171], v[100:115]
    v_mfma_f32_32x32x16_bf16 v[116:131], v[144:147], v[168:171], v[116:131]
    s_waitcnt vmcnt(10)
    ds_read_b64_tr_b16 v[132:133], v4 offset:10240
    ds_read_b64_tr_b16 v[134:135], v4 offset:11264
    ds_read_b64_tr_b16 v[136:137], v5 offset:10240
    ds_read_b64_tr_b16 v[138:139], v5 offset:11264
    s_waitcnt lgkmcnt(8)
    v_mfma_f32_32x32x16_bf16 v[68:83], v[148:151], v[212:215], v[68:83]
    v_mfma_f32_32x32x16_bf16 v[84:99], v[152:155], v[212:215], v[84:99]
    v_mfma_f32_32x32x16_bf16 v[100:115], v[148:151], v[216:219], v[100:115]
    v_mfma_f32_32x32x16_bf16 v[116:131], v[152:155], v[216:219], v[116:131]
    s_waitcnt vmcnt(8)
    ds_read_b64_tr_b16 v[140:141], v4 offset:12288
    ds_read_b64_tr_b16 v[142:143], v4 offset:13312
    ds_read_b64_tr_b16 v[144:145], v5 offset:12288
    ds_read_b64_tr_b16 v[146:147], v5 offset:13312
    s_waitcnt lgkmcnt(8)
    v_mfma_f32_32x32x16_bf16 v[68:83], v[156:159], v[20:23], v[68:83]
    v_mfma_f32_32x32x16_bf16 v[84:99], v[160:163], v[20:23], v[84:99]
    v_mfma_f32_32x32x16_bf16 v[100:115], v[156:159], v[24:27], v[100:115]
    v_mfma_f32_32x32x16_bf16 v[116:131], v[160:163], v[24:27], v[116:131]
    ds_read_b64_tr_b16 v[148:149], v244 offset:0
    ds_read_b64_tr_b16 v[150:151], v244 offset:1024
    ds_read_b64_tr_b16 v[152:153], v245 offset:0
    ds_read_b64_tr_b16 v[154:155], v245 offset:1024
    s_waitcnt vmcnt(6)
    s_waitcnt lgkmcnt(8)
    v_mfma_f32_32x32x16_bf16 v[84:99], v[136:139], v[220:223], v[84:99]
    ds_read_b64_tr_b16 v[156:157], v244 offset:2048
    ds_read_b64_tr_b16 v[158:159], v244 offset:3072
    ds_read_b64_tr_b16 v[160:161], v245 offset:2048
    ds_read_b64_tr_b16 v[162:163], v245 offset:3072
    s_waitcnt vmcnt(4)
    s_waitcnt lgkmcnt(8)
    v_mfma_f32_32x32x16_bf16 v[84:99], v[144:147], v[172:175], v[84:99]
    s_waitcnt vmcnt(2)
    s_waitcnt lgkmcnt(4)
    v_mfma_f32_32x32x16_bf16 v[84:99], v[152:155], v[228:231], v[84:99]
    s_waitcnt vmcnt(0)
    s_waitcnt lgkmcnt(0)
    v_mfma_f32_32x32x16_bf16 v[84:99], v[160:163], v[28:31], v[84:99]
    v_mfma_f32_32x32x16_bf16 v[100:115], v[132:135], v[224:227], v[100:115]
    v_mfma_f32_32x32x16_bf16 v[100:115], v[140:143], v[176:179], v[100:115]
    v_mfma_f32_32x32x16_bf16 v[100:115], v[148:151], v[232:235], v[100:115]
    v_mfma_f32_32x32x16_bf16 v[100:115], v[156:159], v[32:35], v[100:115]
    v_mfma_f32_32x32x16_bf16 v[116:131], v[136:139], v[224:227], v[116:131]
    ds_write_b128 v44, v[84:87] offset:0
    v_mfma_f32_32x32x16_bf16 v[116:131], v[144:147], v[176:179], v[116:131]
    ds_write_b128 v44, v[88:91] offset:1024
    v_mfma_f32_32x32x16_bf16 v[116:131], v[152:155], v[232:235], v[116:131]
    ds_write_b128 v44, v[92:95] offset:2048
    v_mfma_f32_32x32x16_bf16 v[116:131], v[160:163], v[32:35], v[116:131]
    ds_write_b128 v44, v[96:99] offset:3072
    v_mfma_f32_32x32x16_bf16 v[68:83], v[132:135], v[220:223], v[68:83]
    ds_write_b128 v45, v[100:103] offset:0
    v_mfma_f32_32x32x16_bf16 v[68:83], v[140:143], v[172:175], v[68:83]
    ds_write_b128 v45, v[104:107] offset:1024
    v_mfma_f32_32x32x16_bf16 v[68:83], v[148:151], v[228:231], v[68:83]
    ds_write_b128 v45, v[108:111] offset:2048
    v_mfma_f32_32x32x16_bf16 v[68:83], v[156:159], v[28:31], v[68:83]
    ds_write_b128 v45, v[112:115] offset:3072
    ds_write_b128 v46, v[116:119] offset:0
    ds_write_b128 v46, v[120:123] offset:1024
    ds_write_b128 v46, v[124:127] offset:2048
    ds_write_b128 v46, v[128:131] offset:3072
    s_waitcnt lgkmcnt(0)
    s_barrier
    ds_read_b128 v[132:135], v47 offset:0
    ds_read_b128 v[136:139], v47 offset:1024
    ds_read_b128 v[140:143], v47 offset:2048
    ds_read_b128 v[144:147], v47 offset:3072
    ds_read_b128 v[148:151], v47 offset:4096
    ds_read_b128 v[152:155], v47 offset:5120
    ds_read_b128 v[156:159], v47 offset:6144
    ds_read_b128 v[160:163], v47 offset:7168
    ds_read_b128 v[164:167], v47 offset:8192
    ds_read_b128 v[168:171], v47 offset:9216
    ds_read_b128 v[172:175], v47 offset:10240
    ds_read_b128 v[176:179], v47 offset:11264
    s_waitcnt lgkmcnt(8)
    v_pk_add_f32 v[68:69], v[68:69], v[132:133]
    v_pk_add_f32 v[70:71], v[70:71], v[134:135]
    v_pk_add_f32 v[72:73], v[72:73], v[136:137]
    v_pk_add_f32 v[74:75], v[74:75], v[138:139]
    v_pk_add_f32 v[76:77], v[76:77], v[140:141]
    v_pk_add_f32 v[78:79], v[78:79], v[142:143]
    v_pk_add_f32 v[80:81], v[80:81], v[144:145]
    v_pk_add_f32 v[82:83], v[82:83], v[146:147]
    s_waitcnt lgkmcnt(4)
    v_pk_add_f32 v[68:69], v[68:69], v[148:149]
    v_pk_add_f32 v[70:71], v[70:71], v[150:151]
    v_pk_add_f32 v[72:73], v[72:73], v[152:153]
    v_pk_add_f32 v[74:75], v[74:75], v[154:155]
    v_pk_add_f32 v[76:77], v[76:77], v[156:157]
    v_pk_add_f32 v[78:79], v[78:79], v[158:159]
    v_pk_add_f32 v[80:81], v[80:81], v[160:161]
    v_pk_add_f32 v[82:83], v[82:83], v[162:163]
    s_waitcnt lgkmcnt(0)
    v_pk_add_f32 v[68:69], v[68:69], v[164:165]
    v_pk_add_f32 v[70:71], v[70:71], v[166:167]
    v_pk_add_f32 v[72:73], v[72:73], v[168:169]
    v_pk_add_f32 v[74:75], v[74:75], v[170:171]
    v_pk_add_f32 v[76:77], v[76:77], v[172:173]
    v_pk_add_f32 v[78:79], v[78:79], v[174:175]
    v_pk_add_f32 v[80:81], v[80:81], v[176:177]
    v_pk_add_f32 v[82:83], v[82:83], v[178:179]
    v_pk_mul_f32 v[68:69], v[68:69], v[16:17] op_sel_hi:[1,0]
    v_pk_mul_f32 v[70:71], v[70:71], v[16:17] op_sel_hi:[1,0]
    v_pk_mul_f32 v[72:73], v[72:73], v[16:17] op_sel_hi:[1,0]
    v_pk_mul_f32 v[74:75], v[74:75], v[16:17] op_sel_hi:[1,0]
    v_pk_mul_f32 v[76:77], v[76:77], v[16:17] op_sel_hi:[1,0]
    v_pk_mul_f32 v[78:79], v[78:79], v[16:17] op_sel_hi:[1,0]
    v_pk_mul_f32 v[80:81], v[80:81], v[16:17] op_sel_hi:[1,0]
    v_pk_mul_f32 v[82:83], v[82:83], v[16:17] op_sel_hi:[1,0]
    v_cvt_pk_bf16_f32 v68, v68, v69
    v_cvt_pk_bf16_f32 v69, v70, v71
    v_cvt_pk_bf16_f32 v70, v72, v73
    v_cvt_pk_bf16_f32 v71, v74, v75
    v_cvt_pk_bf16_f32 v72, v76, v77
    v_cvt_pk_bf16_f32 v73, v78, v79
    v_cvt_pk_bf16_f32 v74, v80, v81
    v_cvt_pk_bf16_f32 v75, v82, v83
    s_nop 1
    v_permlane32_swap_b32 v68, v70
    v_permlane32_swap_b32 v69, v71
    v_permlane32_swap_b32 v72, v74
    v_permlane32_swap_b32 v73, v75
    s_nop 1
    buffer_store_dwordx4 v[68:71], v19, s[64:67], s71 offen
    buffer_store_dwordx4 v[72:75], v19, s[64:67], s71 offen offset:32
    s_endpgm
L_Bidle:
    s_barrier
    s_lshl_b32 s20, s61, 2
    s_add_u32 s20, s20, s62
    s_sub_u32 s20, s20, 28
    s_cmp_ge_u32 s20, 28
    s_cbranch_scc1 L_Bidle2
    s_and_b32 s29, s3, 1
    s_lshr_b32 s26, s3, 1
    v_lshrrev_b32 v8, 3, v1
    v_and_b32 v9, 7, v1
    v_mul_u32_u24 v11, 3584, v8
    v_bfe_u32 v10, v1, 4, 1
    v_lshlrev_b32 v10, 2, v10
    v_xor_b32 v10, v9, v10
    v_lshl_add_u32 v64, v10, 4, v11
    v_add_u32 v65, 27648, v64
    v_add_u32 v66, 55296, v64
    v_add_u32 v67, 82944, v64
    s_mov_b32 s8, s44
    s_mov_b32 s9, s45
    s_mov_b32 s10, 0x188000
    s_mov_b32 s11, 0x00020000
    s_mov_b32 s12, s46
    s_mov_b32 s13, s47
    s_mov_b32 s14, 0xe00
    s_mov_b32 s15, 0x00020000
    v_lshrrev_b32 v12, 5, v1
    v_bfe_u32 v13, v1, 2, 2
    v_lshl_add_u32 v13, v12, 2, v13
    v_lshlrev_b32 v4, 7, v13
    v_bfe_u32 v13, v1, 3, 1
    v_xor_b32 v13, s29, v13
    v_lshl_add_u32 v4, v13, 6, v4
    v_bfe_u32 v13, v1, 4, 1
    v_lshl_add_u32 v4, v13, 5, v4
    v_and_b32 v13, 3, v1
    v_lshl_add_u32 v4, v13, 3, v4
    s_mul_i32 s31, s26, 802816
    s_lshl_b32 s32, s20, 7
    s_add_u32 s31, s31, s32
    s_mul_i32 s33, s3, 14336
    s_add_u32 s33, s33, 65536
    v_add_u32 v4, s33, v4
    v_and_b32 v8, 31, v1
    v_lshlrev_b32 v9, 1, v8
    s_lshl_b32 s27, s29, 6
    s_add_u32 s27, s27, s32
    buffer_load_ushort v10, v9, s[12:15], s27 offen
    v_mov_b32 v20, 0x3f803f80
    v_mov_b32 v21, 0x3f803f80
    v_mov_b32 v22, 0x3f803f80
    v_mov_b32 v23, 0x3f803f80
    s_add_u32 m0, s33, 0
    s_add_u32 s27, s31, 0
    buffer_load_dwordx4 v64, s[8:11], s27 offen offset:0 lds
    buffer_load_dwordx4 v65, s[8:11], s27 offen offset:1024 lds
    buffer_load_dwordx4 v66, s[8:11], s27 offen offset:2048 lds
    s_waitcnt vmcnt(3)
    buffer_load_dwordx4 v67, s[8:11], s27 offen offset:3072 lds
    s_add_u32 m0, s33, 4096
    s_add_u32 s27, s31, 114688
    s_waitcnt vmcnt(3)
    buffer_load_dwordx4 v64, s[8:11], s27 offen offset:0 lds
    s_waitcnt vmcnt(3)
    buffer_load_dwordx4 v65, s[8:11], s27 offen offset:1024 lds
    s_waitcnt vmcnt(3)
    buffer_load_dwordx4 v66, s[8:11], s27 offen offset:2048 lds
    s_waitcnt vmcnt(3)
    buffer_load_dwordx4 v67, s[8:11], s27 offen offset:3072 lds
    s_add_u32 m0, s33, 8192
    s_add_u32 s27, s31, 229376
    s_waitcnt vmcnt(3)
    buffer_load_dwordx4 v64, s[8:11], s27 offen offset:0 lds
    s_waitcnt vmcnt(3)
    buffer_load_dwordx4 v65, s[8:11], s27 offen offset:1024 lds
    s_waitcnt vmcnt(3)
    buffer_load_dwordx4 v66, s[8:11], s27 offen offset:2048 lds
    s_waitcnt vmcnt(3)
    buffer_load_dwordx4 v67, s[8:11], s27 offen offset:3072 lds
    s_add_u32 m0, s33, 12288
    s_add_u32 s27, s31, 344064
    s_waitcnt vmcnt(3)
    buffer_load_dwordx4 v64, s[8:11], s27 offen offset:0 lds
    s_waitcnt vmcnt(3)
    buffer_load_dwordx4 v65, s[8:11], s27 offen offset:1024 lds
    s_waitcnt vmcnt(0)
    ds_read_b64_tr_b16 v[24:25], v4 offset:0
    ds_read_b64_tr_b16 v[26:27], v4 offset:1024
    ds_read_b64_tr_b16 v[28:29], v4 offset:2048
    ds_read_b64_tr_b16 v[30:31], v4 offset:3072
    ds_read_b64_tr_b16 v[32:33], v4 offset:4096
    ds_read_b64_tr_b16 v[34:35], v4 offset:5120
    ds_read_b64_tr_b16 v[36:37], v4 offset:6144
    ds_read_b64_tr_b16 v[38:39], v4 offset:7168
    ds_read_b64_tr_b16 v[40:41], v4 offset:8192
    ds_read_b64_tr_b16 v[42:43], v4 offset:9216
    ds_read_b64_tr_b16 v[44:45], v4 offset:10240
    ds_read_b64_tr_b16 v[46:47], v4 offset:11264
    ds_read_b64_tr_b16 v[48:49], v4 offset:12288
    ds_read_b64_tr_b16 v[50:51], v4 offset:13312
    s_waitcnt lgkmcnt(0)
    v_mfma_f32_32x32x16_bf16 v[80:95], v[20:23], v[24:27], 0
    v_mfma_f32_32x32x16_bf16 v[80:95], v[20:23], v[28:31], v[80:95]
    v_mfma_f32_32x32x16_bf16 v[80:95], v[20:23], v[32:35], v[80:95]
    v_mfma_f32_32x32x16_bf16 v[80:95], v[20:23], v[36:39], v[80:95]
    v_mfma_f32_32x32x16_bf16 v[80:95], v[20:23], v[40:43], v[80:95]
    v_mfma_f32_32x32x16_bf16 v[80:95], v[20:23], v[44:47], v[80:95]
    v_mfma_f32_32x32x16_bf16 v[80:95], v[20:23], v[48:51], v[80:95]
    s_add_u32 m0, s33, 0
    s_add_u32 s27, s31, 401408
    buffer_load_dwordx4 v64, s[8:11], s27 offen offset:0 lds
    buffer_load_dwordx4 v65, s[8:11], s27 offen offset:1024 lds
    buffer_load_dwordx4 v66, s[8:11], s27 offen offset:2048 lds
    buffer_load_dwordx4 v67, s[8:11], s27 offen offset:3072 lds
    s_add_u32 m0, s33, 4096
    s_add_u32 s27, s31, 516096
    s_waitcnt vmcnt(3)
    buffer_load_dwordx4 v64, s[8:11], s27 offen offset:0 lds
    s_waitcnt vmcnt(3)
    buffer_load_dwordx4 v65, s[8:11], s27 offen offset:1024 lds
    s_waitcnt vmcnt(3)
    buffer_load_dwordx4 v66, s[8:11], s27 offen offset:2048 lds
    s_waitcnt vmcnt(3)
    buffer_load_dwordx4 v67, s[8:11], s27 offen offset:3072 lds
    s_add_u32 m0, s33, 8192
    s_add_u32 s27, s31, 630784
    s_waitcnt vmcnt(3)
    buffer_load_dwordx4 v64, s[8:11], s27 offen offset:0 lds
    s_waitcnt vmcnt(3)
    buffer_load_dwordx4 v65, s[8:11], s27 offen offset:1024 lds
    s_waitcnt vmcnt(3)
    buffer_load_dwordx4 v66, s[8:11], s27 offen offset:2048 lds
    s_waitcnt vmcnt(3)
    buffer_load_dwordx4 v67, s[8:11], s27 offen offset:3072 lds
    s_add_u32 m0, s33, 12288
    s_add_u32 s27, s31, 745472
    s_waitcnt vmcnt(3)
    buffer_load_dwordx4 v64, s[8:11], s27 offen offset:0 lds
    s_waitcnt vmcnt(3)
    buffer_load_dwordx4 v65, s[8:11], s27 offen offset:1024 lds
    s_waitcnt vmcnt(0)
    ds_read_b64_tr_b16 v[24:25], v4 offset:0
    ds_read_b64_tr_b16 v[26:27], v4 offset:1024
    ds_read_b64_tr_b16 v[28:29], v4 offset:2048
    ds_read_b64_tr_b16 v[30:31], v4 offset:3072
    ds_read_b64_tr_b16 v[32:33], v4 offset:4096
    ds_read_b64_tr_b16 v[34:35], v4 offset:5120
    ds_read_b64_tr_b16 v[36:37], v4 offset:6144
    ds_read_b64_tr_b16 v[38:39], v4 offset:7168
    ds_read_b64_tr_b16 v[40:41], v4 offset:8192
    ds_read_b64_tr_b16 v[42:43], v4 offset:9216
    ds_read_b64_tr_b16 v[44:45], v4 offset:10240
    ds_read_b64_tr_b16 v[46:47], v4 offset:11264
    ds_read_b64_tr_b16 v[48:49], v4 offset:12288
    ds_read_b64_tr_b16 v[50:51], v4 offset:13312
    s_waitcnt lgkmcnt(0)
    v_mfma_f32_32x32x16_bf16 v[80:95], v[20:23], v[24:27], v[80:95]
    v_mfma_f32_32x32x16_bf16 v[80:95], v[20:23], v[28:31], v[80:95]
    v_mfma_f32_32x32x16_bf16 v[80:95], v[20:23], v[32:35], v[80:95]
    v_mfma_f32_32x32x16_bf16 v[80:95], v[20:23], v[36:39], v[80:95]
    v_mfma_f32_32x32x16_bf16 v[80:95], v[20:23], v[40:43], v[80:95]
    v_mfma_f32_32x32x16_bf16 v[80:95], v[20:23], v[44:47], v[80:95]
    v_mfma_f32_32x32x16_bf16 v[80:95], v[20:23], v[48:51], v[80:95]
    s_lshl_b32 s27, s20, 1
    s_add_u32 s27, s27, s29
    s_lshl_b32 s27, s27, 9
    s_add_u32 s27, s27, 0xa80000
    s_lshl_b32 s28, s26, 2
    s_add_u32 s28, s28, s27
    v_lshlrev_b32 v9, 4, v8
    v_lshl_or_b32 v10, v10, 16, v10
    v_mov_b32 v11, 0
    s_lshl_b32 s30, s20, 2
    s_add_u32 s30, s30, s3
    s_lshl_b32 s30, s30, 2
    s_add_u32 s30, s30, 0x1608000
    v_and_b32 v12, 0xffff0000, v80
    v_sub_f32 v13, v80, v12
    v_cvt_pk_bf16_f32 v12, v12, v13
    s_mov_b32 exec_hi, 0
    buffer_store_dword v12, v9, s[16:19], s28 offen sc1
    buffer_store_dwordx2 v[10:11], v9, s[16:19], s27 offen offset:8 sc1
    s_mov_b32 exec_hi, -1
    s_waitcnt vmcnt(0)
    v_mov_b32 v14, s60
    s_mov_b64 exec, 1
    buffer_store_dword v14, off, s[16:19], s30 sc1
    s_mov_b64 exec, -1
L_Bidle2:
    s_endpgm
L_slow0:
    buffer_store_dword v9, off, s[16:19], s70 sc1
    s_branch L_back0
L_slow1:
    buffer_store_dwordx4 v[36:39], v2, s[16:19], s70 offen sc1
    buffer_store_dwordx4 v[40:43], v2, s[16:19], s70 offen offset:1024 sc1
    s_branch L_back1
L_slow2:
    buffer_store_dwordx2 v[12:13], v16, s[16:19], s71 offen sc1
    s_branch L_back2
L_slow3:
    buffer_store_dword v24, off, s[16:19], s28 sc1
    s_branch L_back3
L_slow4:
    buffer_store_dword v18, off, s[16:19], s28 sc1
    s_branch L_back4
L_retry:
    s_mov_b32 s33, 1
    s_waitcnt vmcnt(0) lgkmcnt(0)
    s_barrier
    s_mov_b32 exec_lo, 0
    v_mov_b32 v26, 0
    v_mov_b32 v34, 0
    v_mov_b32 v42, 0
    v_mov_b32 v50, 0
    s_mov_b32 exec_lo, -1
    v_mov_b32 v16, 0xff800000
    v_mov_b32 v17, 0xff800000
    v_mov_b32 v18, 0xff800000
    v_mov_b32 v19, 0xff800000
    s_lshl_b32 s32, s21, 18
    s_lshl_b32 s27, s3, 12
    s_add_u32 s32, s32, s27
    s_add_u32 s32, s32, 0x200000
    s_add_u32 s35, s32, 0x40000
L_mloop:
    buffer_load_dwordx4 v[180:183], v2, s[16:19], s32 offen
    buffer_load_dwordx4 v[184:187], v2, s[16:19], s32 offen offset:1024
    s_waitcnt vmcnt(0)
    v_mfma_f32_32x32x16_bf16 v[52:67], v[180:183], v[20:23], 0
    v_mfma_f32_32x32x16_bf16 v[52:67], v[184:187], v[24:27], v[52:67]
    v_mfma_f32_32x32x16_bf16 v[68:83], v[180:183], v[28:31], 0
    v_mfma_f32_32x32x16_bf16 v[68:83], v[184:187], v[32:35], v[68:83]
    v_mfma_f32_32x32x16_bf16 v[84:99], v[180:183], v[36:39], 0
    v_mfma_f32_32x32x16_bf16 v[84:99], v[184:187], v[40:43], v[84:99]
    v_mfma_f32_32x32x16_bf16 v[100:115], v[180:183], v[44:47], 0
    v_mfma_f32_32x32x16_bf16 v[100:115], v[184:187], v[48:51], v[100:115]
    s_nop 7
    s_nop 7
    v_max3_f32 v16, v16, v52, v53
    v_max3_f32 v17, v17, v68, v69
    v_max3_f32 v18, v18, v84, v85
    v_max3_f32 v19, v19, v100, v101
    v_max3_f32 v16, v16, v54, v55
    v_max3_f32 v17, v17, v70, v71
    v_max3_f32 v18, v18, v86, v87
    v_max3_f32 v19, v19, v102, v103
    v_max3_f32 v16, v16, v56, v57
    v_max3_f32 v17, v17, v72, v73
    v_max3_f32 v18, v18, v88, v89
    v_max3_f32 v19, v19, v104, v105
    v_max3_f32 v16, v16, v58, v59
    v_max3_f32 v17, v17, v74, v75
    v_max3_f32 v18, v18, v90, v91
    v_max3_f32 v19, v19, v106, v107
    v_max3_f32 v16, v16, v60, v61
    v_max3_f32 v17, v17, v76, v77
    v_max3_f32 v18, v18, v92, v93
    v_max3_f32 v19, v19, v108, v109
    v_max3_f32 v16, v16, v62, v63
    v_max3_f32 v17, v17, v78, v79
    v_max3_f32 v18, v18, v94, v95
    v_max3_f32 v19, v19, v110, v111
    v_max3_f32 v16, v16, v64, v65
    v_max3_f32 v17, v17, v80, v81
    v_max3_f32 v18, v18, v96, v97
    v_max3_f32 v19, v19, v112, v113
    v_max3_f32 v16, v16, v66, v67
    v_max3_f32 v17, v17, v82, v83
    v_max3_f32 v18, v18, v98, v99
    v_max3_f32 v19, v19, v114, v115
    s_add_u32 s32, s32, 16384
    s_cmp_lt_u32 s32, s35
    s_cbranch_scc1 L_mloop
    v_mov_b32 v4, v16
    v_mov_b32 v5, v17
    v_mov_b32 v6, v18
    v_mov_b32 v7, v19
    s_nop 0
    v_permlane32_swap_b32 v16, v4
    v_permlane32_swap_b32 v17, v5
    v_permlane32_swap_b32 v18, v6
    v_permlane32_swap_b32 v19, v7
    v_max_f32 v16, v16, v4
    v_max_f32 v17, v17, v5
    v_max_f32 v18, v18, v6
    v_max_f32 v19, v19, v7
    s_add_u32 s27, s3, 1
    s_and_b32 s27, s27, 3
    s_lshl_b32 s27, s27, 8
    v_lshl_add_u32 v4, v1, 2, s27
    s_add_u32 s27, s3, 2
    s_and_b32 s27, s27, 3
    s_lshl_b32 s27, s27, 8
    v_lshl_add_u32 v5, v1, 2, s27
    s_add_u32 s27, s3, 3
    s_and_b32 s27, s27, 3
    s_lshl_b32 s27, s27, 8
    v_lshl_add_u32 v6, v1, 2, s27
    s_add_u32 s27, s3, 4
    s_and_b32 s27, s27, 3
    s_lshl_b32 s27, s27, 8
    v_lshl_add_u32 v7, v1, 2, s27
    s_lshl_b32 s27, s3, 10
    v_add_u32 v8, s27, v4
    ds_write_b32 v8, v16
    v_add_u32 v8, s27, v5
    ds_write_b32 v8, v17
    v_add_u32 v8, s27, v6
    ds_write_b32 v8, v18
    v_add_u32 v8, s27, v7
    ds_write_b32 v8, v19
    s_waitcnt lgkmcnt(0)
    s_barrier
    ds_read_b32 v52, v4 offset:0
    ds_read_b32 v53, v4 offset:1024
    ds_read_b32 v54, v4 offset:2048
    ds_read_b32 v55, v4 offset:3072
    s_waitcnt lgkmcnt(0)
    v_max3_f32 v16, v52, v53, v54
    v_max_f32 v16, v16, v55
    ds_read_b32 v56, v5 offset:0
    ds_read_b32 v57, v5 offset:1024
    ds_read_b32 v58, v5 offset:2048
    ds_read_b32 v59, v5 offset:3072
    s_waitcnt lgkmcnt(0)
    v_max3_f32 v17, v56, v57, v58
    v_max_f32 v17, v17, v59
    ds_read_b32 v60, v6 offset:0
    ds_read_b32 v61, v6 offset:1024
    ds_read_b32 v62, v6 offset:2048
    ds_read_b32 v63, v6 offset:3072
    s_waitcnt lgkmcnt(0)
    v_max3_f32 v18, v60, v61, v62
    v_max_f32 v18, v18, v63
    ds_read_b32 v64, v7 offset:0
    ds_read_b32 v65, v7 offset:1024
    ds_read_b32 v66, v7 offset:2048
    ds_read_b32 v67, v7 offset:3072
    s_waitcnt lgkmcnt(0)
    v_max3_f32 v19, v64, v65, v66
    v_max_f32 v19, v19, v67
    s_barrier
    v_and_b32 v4, 0xffff0000, v16
    v_and_b32 v5, 0xffff0000, v17
    v_and_b32 v6, 0xffff0000, v18
    v_and_b32 v7, 0xffff0000, v19
    v_sub_f32 v16, v4, v16
    v_sub_f32 v17, v5, v17
    v_sub_f32 v18, v6, v18
    v_sub_f32 v19, v7, v19
    v_cvt_pk_bf16_f32 v4, -v4, v16
    v_cvt_pk_bf16_f32 v5, -v5, v17
    v_cvt_pk_bf16_f32 v6, -v6, v18
    v_cvt_pk_bf16_f32 v7, -v7, v19
    s_mov_b32 exec_lo, 0
    v_mov_b32 v26, v4
    v_mov_b32 v34, v5
    v_mov_b32 v42, v6
    v_mov_b32 v50, v7
    s_mov_b32 exec_lo, -1
    s_lshl_b32 s27, s22, 14
    s_add_u32 s27, s27, s35
    s_sub_u32 s27, s27, 0x40000
    s_add_u32 s26, s56, s27
    s_addc_u32 s27, s57, 0
    global_load_dwordx4 v[180:183], v2, s[26:27]
    global_load_dwordx4 v[184:187], v2, s[26:27] offset:1024
    global_load_dwordx4 v[188:191], v2, s[26:27] offset:2048
    global_load_dwordx4 v[192:195], v2, s[26:27] offset:3072
    v_mov_b32 v116, 0
    v_mov_b32 v117, 0
    v_mov_b32 v118, 0
    v_mov_b32 v119, 0
    v_mov_b32 v120, 0
    v_mov_b32 v121, 0
    v_mov_b32 v122, 0
    v_mov_b32 v123, 0
    v_mov_b32 v124, 0
    v_mov_b32 v125, 0
    v_mov_b32 v126, 0
    v_mov_b32 v127, 0
    v_mov_b32 v128, 0
    v_mov_b32 v129, 0
    v_mov_b32 v130, 0
    v_mov_b32 v131, 0
    v_mov_b32 v132, 0
    v_mov_b32 v133, 0
    v_mov_b32 v134, 0
    v_mov_b32 v135, 0
    v_mov_b32 v136, 0
    v_mov_b32 v137, 0
    v_mov_b32 v138, 0
    v_mov_b32 v139, 0
    v_mov_b32 v140, 0
    v_mov_b32 v141, 0
    v_mov_b32 v142, 0
    v_mov_b32 v143, 0
    v_mov_b32 v144, 0
    v_mov_b32 v145, 0
    v_mov_b32 v146, 0
    v_mov_b32 v147, 0
    v_mov_b32 v148, 0
    v_mov_b32 v149, 0
    v_mov_b32 v150, 0
    v_mov_b32 v151, 0
    v_mov_b32 v152, 0
    v_mov_b32 v153, 0
    v_mov_b32 v154, 0
    v_mov_b32 v155, 0
    v_mov_b32 v156, 0
    v_mov_b32 v157, 0
    v_mov_b32 v158, 0
    v_mov_b32 v159, 0
    v_mov_b32 v160, 0
    v_mov_b32 v161, 0
    v_mov_b32 v162, 0
    v_mov_b32 v163, 0
    v_mov_b32 v164, 0
    v_mov_b32 v165, 0
    v_mov_b32 v166, 0
    v_mov_b32 v167, 0
    v_mov_b32 v168, 0
    v_mov_b32 v169, 0
    v_mov_b32 v170, 0
    v_mov_b32 v171, 0
    v_mov_b32 v172, 0
    v_mov_b32 v173, 0
    v_mov_b32 v174, 0
    v_mov_b32 v175, 0
    v_mov_b32 v176, 0
    v_mov_b32 v177, 0
    v_mov_b32 v178, 0
    v_mov_b32 v179, 0
    s_waitcnt vmcnt(0)
    s_branch L_setm
L_codeend:
.section .rodata,"a"
.p2align 6
.amdhsa_kernel sequential_preLN__softmax_full_mha__dense_activation_squared_relu__prompt_kernel
  .amdhsa_next_free_vgpr 256
  .amdhsa_next_free_sgpr 102
  .amdhsa_accum_offset 256
  .amdhsa_group_segment_fixed_size 0
  .amdhsa_kernarg_size 88
  .amdhsa_user_sgpr_count 2
  .amdhsa_user_sgpr_kernarg_segment_ptr 1
  .amdhsa_system_sgpr_workgroup_id_x 1
.end_amdhsa_kernel
```
